```python
import torch

def _softmax(x, axis=-1):
    return torch.softmax(x, dim=axis)
def _gelu(x):
    return torch.nn.functional.gelu(x, approximate="tanh")
def _silu(x):
    return torch.nn.functional.silu(x)
def _sigmoid(x):
    return torch.sigmoid(x)
def _layernorm(x, axis=-1, eps=1e-5):
    m = x.mean(dim=axis, keepdim=True)
    v = x.var(dim=axis, keepdim=True, unbiased=False)
    return (x - m) / torch.sqrt(v + eps)
def _scatter_add(tgt, idx, src, axis=0):
    return tgt.clone().index_add_(axis, idx, src)
def _segment_sum(src, seg, n):
    out = torch.zeros((n,) + src.shape[1:], dtype=src.dtype)
    return out.index_add_(0, seg, src)
def _pad(x, pw):
    flat = tuple(v for pair in reversed(pw) for v in pair)
    return torch.nn.functional.pad(x, flat)

kernel_name = 'concat_heads__ssm_conv_s4__ssm_conv_h3__prompt'

def setup_inputs():

    _w = (lambda a: (lambda t: t.to(torch.bfloat16) if t.is_floating_point() else t)(torch.as_tensor(a)))
    def _A_setup():
        B, L, D, N = 1, 2048, 576, 128
        A_re = -(lambda _x: torch.exp(torch.as_tensor(_x)))((lambda *s: torch.randn(*s, dtype=torch.bfloat16) * 6.4)(D, N))
        A_im = torch.pi * (lambda *s: torch.randn(*s, dtype=torch.bfloat16) * 0.05)(D, N)
        B_re = (lambda *s: torch.randn(*s, dtype=torch.bfloat16) * 0.1)(D, N)
        B_im = (lambda *s: torch.randn(*s, dtype=torch.bfloat16) * 0.1)(D, N)
        C_re = (lambda *s: torch.randn(*s, dtype=torch.bfloat16) * 0.1)(D, N)
        C_im = (lambda *s: torch.randn(*s, dtype=torch.bfloat16) * 0.1)(D, N)
        log_dt = (lambda *s: torch.randn(*s, dtype=torch.bfloat16) * 0.05)(D) * 0.5 - 4.0
        Dskip = (lambda *s: torch.randn(*s, dtype=torch.bfloat16) * 0.05)(D)
        return {
            "u": _w((lambda *s: torch.randn(*s, dtype=torch.bfloat16) * 0.05)(B, L, D)),
            "A_re": _w(A_re),
            "A_im": _w(A_im),
            "B_re": _w(B_re),
            "B_im": _w(B_im),
            "C_re": _w(C_re),
            "C_im": _w(C_im),
            "log_dt": _w(log_dt),
            "Dskip": _w(Dskip),
        }
    _A_in = _A_setup()

    def _B_setup():
        B, S, D = 1, 2048, 576
        ks = 4
        return {
            "q": _w((lambda *s: torch.randn(*s, dtype=torch.bfloat16) * 0.05)(B, S, D)),
            "k": _w((lambda *s: torch.randn(*s, dtype=torch.bfloat16) * 0.4)(B, S, D)),
            "v": _w((lambda *s: torch.randn(*s, dtype=torch.bfloat16) * 0.4)(B, S, D)),
            "shift_k": _w((lambda *s: torch.randn(*s, dtype=torch.bfloat16) * 0.4)(D, ks) * 0.5),
            "ssm_k": _w((lambda *s: torch.randn(*s, dtype=torch.bfloat16) * 0.4)(D, S) * (1.0 / S ** 0.5)),
            "ssm_D": _w((lambda *s: torch.randn(*s, dtype=torch.bfloat16) * 0.4)(D)),
        }
    _B_in = _B_setup()

    return {
        "A_u": _A_in["u"],
        "A_A_re": _A_in["A_re"],
        "A_A_im": _A_in["A_im"],
        "A_B_re": _A_in["B_re"],
        "A_B_im": _A_in["B_im"],
        "A_C_re": _A_in["C_re"],
        "A_C_im": _A_in["C_im"],
        "A_log_dt": _A_in["log_dt"],
        "A_Dskip": _A_in["Dskip"],
        "B_q": _B_in["q"],
        "B_k": _B_in["k"],
        "B_v": _B_in["v"],
        "B_shift_k": _B_in["shift_k"],
        "B_ssm_k": _B_in["ssm_k"],
        "B_ssm_D": _B_in["ssm_D"],
    }

def reference(A_u, A_A_re, A_A_im, A_B_re, A_B_im, A_C_re, A_C_im, A_log_dt, A_Dskip, B_q, B_k, B_v, B_shift_k, B_ssm_k, B_ssm_D):
    def _A_ref(u, A_re, A_im, B_re, B_im, C_re, C_im, log_dt, Dskip):
        Bsz, L, D = u.shape
        dt = torch.exp(log_dt)[:, None]
        A = A_re + 1j * A_im
        Bc = B_re + 1j * B_im
        Cc = C_re + 1j * C_im
        logdA = dt * A
        dB = dt * Bc
        l = (lambda x, dt: x.to(dt))(torch.arange(L), A_re.dtype)
        P = torch.exp(logdA[:, :, None] * l[None, None, :])
        K = torch.einsum("dn,dnl,dn->dl", Cc, P, dB).real
        L2 = 2 * L
        Kp = _pad(K, ((0, 0), (0, L)))
        up = (lambda x, *d: x.permute(*d))(u, 0, 2, 1)
        up = _pad(up, ((0, 0), (0, 0), (0, L)))
        Kf = (lambda x, axes=(-2,-1): torch.fft.rfft2(x.float(), dim=axes))(Kp[:, None, :], axes=(-2, -1))
        Uf = (lambda x, axes=(-2,-1): torch.fft.rfft2(x.float(), dim=axes))(up[:, :, None, :], axes=(-2, -1))
        Yf = Uf * Kf[None, :, :, :]
        y = (lambda x, s, axes=(-2,-1): torch.fft.irfft2(x, s=s, dim=axes).to(torch.bfloat16))(Yf, (1, L2), axes=(-2, -1))[:, :, 0, :L]
        y = (lambda x, *d: x.permute(*d))(y, 0, 2, 1) + u * Dskip[None, None, :]
        return y

    def _B_ref(q, k, v, shift_k, ssm_k, ssm_D):
        B, S, D = q.shape
        ks = shift_k.shape[-1]
        k_pad = _pad(k, ((0, 0), (ks - 1, 0), (0, 0)))
        k_shift = torch.zeros_like(k)
        for t in range(ks):
            k_shift = k_shift + k_pad[:, t:t + S, :] * shift_k[:, ks - 1 - t][None, None, :]
        kv = k_shift * v
        L = 2 * S
        kv_pad = _pad(kv, ((0, 0), (0, S), (0, 0)))
        kf_pad = _pad(ssm_k, ((0, 0), (0, S)))
        kv_f = (lambda x, axes=(-2,-1): torch.fft.rfft2(x.float(), dim=axes))(kv_pad[:, None, :, :], axes=(1, 2))
        kf_f = (lambda x, axes=(-2,-1): torch.fft.rfft2(x.float(), dim=axes))(kf_pad[:, None, :], axes=(1, 2))
        kf_f = (lambda x, *d: x.permute(*d))(kf_f, 1, 2, 0)
        y_f = kv_f * kf_f[None, :, :, :]
        y = (lambda x, s, axes=(-2,-1): torch.fft.irfft2(x, s=s, dim=axes).to(torch.bfloat16))(y_f, (1, L), axes=(1, 2))[:, 0, :S, :]
        y = y + kv * ssm_D[None, None, :]
        return q * y

    a = _A_ref(A_u, A_A_re, A_A_im, A_B_re, A_B_im, A_C_re, A_C_im, A_log_dt, A_Dskip)
    b = _B_ref(B_q, B_k, B_v, B_shift_k, B_ssm_k, B_ssm_D)
    return torch.concatenate([a, b], axis=-1)
```

```asm
; @launch grid=(256,1,1) block=(512,1,1) lds=156080
.amdgcn_target "amdgcn-amd-amdhsa--gfx950"
.text
.globl concat_heads__ssm_conv_s4__ssm_conv_h3__prompt_kernel
.p2align 8
.type concat_heads__ssm_conv_s4__ssm_conv_h3__prompt_kernel,@function
concat_heads__ssm_conv_s4__ssm_conv_h3__prompt_kernel:
s_load_dword s64, s[0:1], 0
s_load_dword s65, s[0:1], 64
s_mov_b32 s63, 0
s_cmp_ge_u32 s2, 256
s_cbranch_scc1 L_end
v_lshrrev_b32 v1, 6, v0
s_and_b32 s35, s2, 7
s_lshr_b32 s34, s2, 3
v_readfirstlane_b32 s3, v1
s_getpc_b64 s[36:37]
s_mov_b32 s38, ((L_last - L_cp) / 128 + 7) / 8
s_mul_i32 s39, s38, s34
v_add_u32 v2, s39, v0
v_min_u32 v2, (L_last - L_cp) / 128, v2
v_lshlrev_b32 v2, 7, v2
v_mov_b32 v3, s37
v_add_co_u32 v2, vcc, s36, v2
s_cmp_lt_u32 s34, 8
s_cselect_b32 s38, s38, 0
v_addc_co_u32 v3, vcc, 0, v3, vcc
v_cmp_gt_u32 vcc, s38, v0
s_and_saveexec_b64 s[38:39], vcc
s_cbranch_execz L_cp
global_load_dword v247, v[2:3], off
L_cp:
s_mov_b64 exec, -1
s_cmp_lt_u32 s35, 4
s_cselect_b32 s36, 10, 8
s_cselect_b32 s37, 16, 20
s_cmp_lt_u32 s34, s36
s_cbranch_scc1 L_B
s_sub_u32 s34, s34, s36
s_cmp_lt_u32 s34, s37
s_cbranch_scc1 L_A
s_sub_u32 s34, s34, s37
s_branch L_P
L_B:
s_load_dwordx2 s[8:9], s[0:1], 0x68
s_load_dwordx2 s[12:13], s[0:1], 0x50
s_load_dwordx2 s[16:17], s[0:1], 0x58
s_load_dwordx2 s[28:29], s[0:1], 0x60
s_load_dwordx2 s[20:21], s[0:1], 0x48
s_load_dwordx2 s[32:33], s[0:1], 0x70
s_load_dwordx2 s[24:25], s[0:1], 0x78
s_lshl_b32 s36, s35, 3
s_lshl_b32 s35, s35, 1
s_add_u32 s35, s35, 56
s_cmp_lt_u32 s34, 8
s_cselect_b32 s35, s36, s35
s_add_u32 s34, s34, s35
s_lshl_b32 s36, s34, 3
s_add_u32 s36, s36, s3
s_lshl_b32 s37, s36, 12
s_mul_i32 s38, s3, 0x10c0
s_add_u32 m0, s38, 0x60
s_mov_b32 s10, 0x240000
s_mov_b32 s11, 0x20000
v_and_b32 v1, 63, v0
v_lshlrev_b32 v2, 4, v1
s_waitcnt lgkmcnt(0)
buffer_load_dwordx4 v2, s[8:11], s37 offen nt lds
buffer_load_dwordx4 v2, s[8:11], s37 offen offset:1024 nt lds
buffer_load_dwordx4 v2, s[8:11], s37 offen offset:2048 nt lds
buffer_load_dwordx4 v2, s[8:11], s37 offen offset:3072 nt lds
s_branch L_B2
L_A:
s_setprio 3
s_load_dwordx4 s[4:7], s[0:1], 0x50
s_load_dwordx16 s[8:23], s[0:1], 0
s_load_dwordx2 s[28:29], s[0:1], 64
s_load_dwordx2 s[40:41], s[0:1], 0
s_load_dwordx2 s[24:25], s[0:1], 0x78
s_mov_b32 s33, s35
s_mov_b32 s30, s34
s_min_u32 s48, s30, 15
s_lshl_b32 s48, s48, 2
s_and_b32 s47, s3, 3
s_add_u32 s48, s48, s47
s_mul_i32 s48, s48, 0x2400
s_lshl_b32 s47, s33, 7
s_add_u32 s52, s48, s47
v_and_b32 v1, 63, v0
v_mul_u32_u24 v2, 0x480, v1
v_add_u32 v2, s52, v2
v_mov_b32 v104, 0
s_lshl_b32 s47, s33, 3
s_and_b32 s48, s30, 7
s_add_u32 s34, s47, s48
s_lshl_b32 s47, s33, 1
s_and_b32 s48, s30, 1
s_add_u32 s47, s47, s48
s_add_u32 s47, s47, 56
s_cmp_lt_u32 s30, 16
s_cselect_b32 s34, s34, s47
s_lshl_b32 s36, s34, 3
s_add_u32 s36, s36, s3
s_lshl_b32 s37, s36, 8
v_lshl_add_u32 v3, v1, 2, s37
s_cmp_lt_u32 s3, 4
s_waitcnt lgkmcnt(0)
s_cselect_b64 s[48:49], s[4:5], s[6:7]
s_mov_b64 exec, 0xff
global_load_dword v104, v2, s[48:49]
s_mov_b64 exec, -1
global_load_dword v4, v3, s[10:11] nt
global_load_dword v5, v3, s[12:13] nt
global_load_dword v6, v3, s[14:15] nt
global_load_dword v7, v3, s[16:17] nt
global_load_dword v8, v3, s[18:19] nt
global_load_dword v9, v3, s[20:21] nt
s_branch L_A2
L_P:
s_load_dwordx2 s[8:9], s[0:1], 0x48
s_load_dwordx2 s[12:13], s[0:1], 0x50
s_load_dwordx2 s[16:17], s[0:1], 0x58
s_mov_b32 s10, 0x240000
s_mov_b32 s11, 0x20000
s_mov_b32 s14, 0x240000
s_mov_b32 s15, 0x20000
s_mov_b32 s18, 0x240000
s_mov_b32 s19, 0x20000
s_cmp_lt_u32 s35, 4
s_cselect_b32 s40, 11, 8
s_cselect_b32 s41, 1, 0
s_mov_b32 s42, 0xff
s_cselect_b32 s42, 0x1ff, s42
s_mov_b32 s43, 0xff
s_cselect_b32 s43, 0x7ff, s43
s_lshl_b32 s48, s34, 3
s_add_u32 s48, s48, s3
s_mul_i32 s48, s48, s40
s_lshl_b32 s47, s35, 7
s_sub_u32 s49, 0x400, s47
v_and_b32 v2, 31, v0
v_add_u32 v2, s48, v2
v_min_u32 v2, s42, v2
v_and_b32 v3, s41, v2
v_cmp_eq_u32 s[52:53], 0, v3
v_lshrrev_b32 v2, s41, v2
v_mul_u32_u24 v3, s49, v3
v_bfe_u32 v5, v0, 5, 1
v_lshl_add_u32 v2, v5, 8, v2
v_mul_u32_u24 v2, 0x480, v2
v_add3_u32 v2, v2, v3, s47
v_mov_b32 v5, 0
s_lshl_b32 s48, s34, 3
s_add_u32 s48, s48, s3
s_mul_i32 s48, s48, 11
v_and_b32 v6, 63, v0
v_add_u32 v6, s48, v6
v_min_u32 v6, 0x1ff, v6
v_mul_u32_u24 v6, 0x480, v6
v_add_u32 v6, 0x400, v6
s_waitcnt lgkmcnt(0)
s_cmp_ge_u32 s35, 4
s_cbranch_scc1 L_p8
s_mov_b64 exec, 0x7ff
buffer_load_dword v5, v6, s[12:15], 0 offen
buffer_load_dword v5, v6, s[16:19], 0 offen
L_p8:
s_barrier
s_waitcnt vmcnt(0)
s_mov_b32 exec_lo, s43
s_mov_b32 exec_hi, s43
s_mov_b32 s47, 0
buffer_load_dword v5, v2, s[8:11], s47 offen
s_barrier
s_mov_b32 exec_lo, s43
s_mov_b32 exec_hi, s43
s_mov_b32 s47, 0x1b0000
buffer_load_dword v5, v2, s[12:15], s47 offen
s_barrier
s_mov_b32 exec_lo, s43
s_mov_b32 exec_hi, s43
s_mov_b32 s47, 0x1b0000
buffer_load_dword v5, v2, s[16:19], s47 offen
s_barrier
s_mov_b32 exec_lo, s43
s_mov_b32 exec_hi, s43
s_mov_b32 s47, 0x90000
buffer_load_dword v5, v2, s[8:11], s47 offen
s_barrier
s_mov_b32 exec_lo, s43
s_mov_b32 exec_hi, s43
s_mov_b32 s47, 0x120000
buffer_load_dword v5, v2, s[8:11], s47 offen
s_barrier
s_mov_b32 exec_lo, s43
s_mov_b32 exec_hi, s43
s_mov_b32 s47, 0x1b0000
buffer_load_dword v5, v2, s[8:11], s47 offen
s_barrier
s_endpgm
.p2align 6
L_B2:
s_mov_b32 s14, 0x240000
s_mov_b32 s15, 0x20000
s_mov_b32 s18, 0x240000
s_mov_b32 s19, 0x20000
s_mov_b32 s22, 0x240000
s_mov_b32 s23, 0x20000
s_mov_b32 s26, 0x480000
s_mov_b32 s27, 0x20000
s_lshl_b32 s35, s34, 4
s_mul_i32 s39, s3, 0x10a0
s_add_u32 s39, s39, 0x8600
s_lshl_b32 s40, s3, 10
s_add_u32 s40, s40, 0x18c00
s_mov_b32 s55, s3
s_mul_i32 s41, s55, 0x12000
s_mul_i32 s42, s3, 0x1020
s_add_u32 s42, s42, 0x10b00
s_lshl_b32 s43, s36, 1
s_and_b32 s44, s43, -4
s_lshl_b32 s49, s36, 3
v_bfe_u32 v2, v0, 4, 2
v_bfe_u32 v3, v0, 2, 2
v_and_b32 v4, 3, v0
v_and_b32 v52, 35, v1
v_lshl_add_u32 v52, v3, 3, v52
v_and_b32 v5, 1, v2
v_lshl_add_u32 v52, v5, 2, v52
v_mul_u32_u24 v52, 0x480, v52
v_add_u32 v52, s35, v52
s_load_dword s45, s[32:33], s44
s_load_dword s46, s[8:9], s37
s_load_dwordx2 s[30:31], s[28:29], s49
s_cmp_lt_u32 s3, 4
s_cselect_b64 s[4:5], s[12:13], s[16:17]
s_mov_b32 s6, 0x240000
s_mov_b32 s7, 0x20000
s_mov_b32 s54, 0x10a0
s_cselect_b32 s54, 0x1020, s54
s_mov_b32 s53, 0x84a0
s_cselect_b32 s53, 0x10b20, s53
s_and_b32 s52, s3, 3
s_mul_i32 s52, s52, 0x12000
s_barrier
s_setprio 3
s_add_u32 m0, s40, 0
s_add_u32 s47, s52, 0
buffer_load_dwordx4 v52, s[4:7], s47 offen lds
s_add_u32 m0, s40, 0x4000
s_add_u32 s47, s52, 0x48000
buffer_load_dwordx4 v52, s[4:7], s47 offen lds
v_lshlrev_b32 v0, 2, v2
v_add_u32 v0, v0, v3
v_lshlrev_b32 v6, 2, v4
v_sub_u32 v6, v6, v0
v_lshlrev_b32 v6, 3, v6
v_add_u32 v6, 0x78, v6
v_add_u32 v6, s38, v6
v_add_u32 v214, v0, v4
v_lshlrev_b32 v214, 3, v214
v_add_u32 v214, 8, v214
v_add_u32 v214, s39, v214
v_lshrrev_b32 v7, 1, v2
v_lshl_add_u32 v215, v4, 2, v3
v_lshl_add_u32 v215, v7, 5, v215
v_lshlrev_b32 v215, 4, v215
v_lshl_add_u32 v215, v5, 3, v215
v_add_u32 v215, s40, v215
v_lshl_add_u32 v8, v5, 2, v4
v_lshl_add_u32 v9, v7, 2, v3
v_lshlrev_b32 v9, 4, v9
s_lshl_b32 s47, s3, 7
v_mul_u32_u24 v34, s54, v8
v_add_u32 v34, v34, v9
s_add_u32 s53, s53, s47
v_add_u32 v34, s53, v34
s_lshl_b32 s47, s55, 7
v_add_u32 v9, s47, v9
v_mul_u32_u24 v216, 0x10a0, v8
v_add_u32 v216, v216, v9
v_add_u32 v216, 0x86a0, v216
v_mul_u32_u24 v217, 0x1020, v8
v_add_u32 v217, v217, v9
v_add_u32 v217, 0x10b20, v217
v_mul_u32_u24 v218, 0x10c0, v8
v_add_u32 v218, v218, v9
v_lshl_add_u32 v219, v1, 2, s38
s_setprio 2
v_mul_u32_u24 v0, 0x10c0, v3
v_lshl_add_u32 v0, v2, 5, v0
v_lshl_add_u32 v0, v4, 3, v0
v_and_b32 v10, 15, v1
v_lshlrev_b32 v9, 5, v10
v_lshl_add_u32 v220, v2, 4, v9
v_add_u32 v220, s42, v220
v_lshl_add_u32 v221, v2, 3, v9
s_add_u32 s47, s39, 0xa0
v_add_u32 v221, s47, v221
s_add_u32 s47, s35, 0x480
v_lshlrev_b32 v222, 3, v2
v_lshl_add_u32 v222, v3, 1, v222
v_lshrrev_b32 v8, 1, v4
v_add_u32 v222, v222, v8
v_and_b32 v8, 1, v4
v_lshl_add_u32 v222, v8, 6, v222
v_mul_u32_u24 v222, 0x900, v222
v_add_u32 v222, s47, v222
v_lshlrev_b32 v223, 4, v7
v_lshl_add_u32 v223, v3, 2, v223
v_lshl_add_u32 v223, v5, 1, v223
v_lshrrev_b32 v9, 1, v4
v_add_u32 v223, v223, v9
v_and_b32 v9, 1, v4
v_lshl_add_u32 v223, v9, 6, v223
v_mul_u32_u24 v223, 0x480, v223
v_add_u32 v223, s35, v223
s_lshr_b32 s47, s55, 1
s_lshl_b32 s47, s47, 2
s_and_b32 s48, s55, 1
s_add_u32 s47, s47, s48
s_mul_i32 s34, s47, 0x9000
s_mul_i32 s49, s3, 0x80
v_add_u32 v224, s49, v0
s_and_b32 s48, s49, 0xff
s_lshr_b32 s48, s48, 2
s_lshr_b32 s47, s49, 8
s_lshl_b32 s47, s47, 7
s_add_u32 s48, s48, s47
s_mul_i32 s36, s48, 0x900
s_mul_i32 s49, s3, 64
v_add_u32 v225, s49, v0
s_and_b32 s48, s49, 0xff
s_lshr_b32 s48, s48, 2
s_lshr_b32 s47, s49, 8
s_setprio 1
s_lshl_b32 s47, s47, 7
s_add_u32 s48, s48, s47
s_mul_i32 s35, s48, 0x900
v_mov_b32 v3, 0
v_lshlrev_b32 v9, 2, v1
v_add_u32 v4, s39, v9
v_add_u32 v5, s38, v9
v_add_u32 v7, s42, v9
s_mov_b64 exec, 0xff
ds_write_b32 v7, v3
s_mov_b64 exec, 0xffffff
ds_write_b32 v5, v3
s_mov_b32 exec_lo, -1
s_mov_b32 exec_hi, 0xff
ds_write_b32 v4, v3
s_mov_b64 exec, -1
v_mov_b32 v0, 0
v_lshlrev_b32 v8, 2, v1
v_and_b32 v226, 28, v8
v_add_u32 v226, 0x24c00, v226
v_add_u32 v8, 0x24c00, v8
ds_write_b32 v8, v0
s_lshl_b32 s47, s3, 2
s_add_u32 s47, s47, 0x24c00
v_mov_b32 v227, s47
v_mov_b32 v228, 1
s_waitcnt lgkmcnt(0)
s_lshr_b32 s47, s31, 16
s_lshl_b32 s48, s31, 16
s_or_b32 s50, s47, s48
s_lshr_b32 s47, s30, 16
s_lshl_b32 s48, s30, 16
s_or_b32 s51, s47, s48
v_lshlrev_b32 v1, 3, v2
v_sub_u32 v1, v10, v1
v_lshlrev_b32 v1, 4, v1
v_add_u32 v0, 0xd0, v1
v_sub_u32 v3, 0, v0
v_lshlrev_b64 v[4:5], v0, s[50:51]
v_lshrrev_b64 v[8:9], v3, s[50:51]
v_cmp_gt_u32 s[52:53], 64, v0
v_cmp_gt_u32 s[54:55], 64, v3
s_nop 1
v_cndmask_b32 v54, 0, v8, s[54:55]
v_cndmask_b32 v55, 0, v9, s[54:55]
v_cndmask_b32 v54, v54, v4, s[52:53]
v_cndmask_b32 v55, v55, v5, s[52:53]
v_add_u32 v2, 0x90, v1
v_sub_u32 v7, 0, v2
v_lshlrev_b64 v[4:5], v2, s[50:51]
s_setprio 0
v_lshrrev_b64 v[8:9], v7, s[50:51]
v_cmp_gt_u32 s[52:53], 64, v2
v_cmp_gt_u32 s[54:55], 64, v7
s_nop 1
v_cndmask_b32 v56, 0, v8, s[54:55]
v_cndmask_b32 v57, 0, v9, s[54:55]
v_cndmask_b32 v56, v56, v4, s[52:53]
v_cndmask_b32 v57, v57, v5, s[52:53]
s_and_b32 s43, s43, 2
s_lshl_b32 s43, s43, 3
s_lshr_b32 s45, s45, s43
s_lshl_b32 s45, s45, 16
s_lshl_b32 s46, s46, 16
v_mov_b32 v0, s45
v_add_f32 v0, s46, v0
v_cvt_pk_bf16_f32 v0, v0, v0
v_mov_b32 v1, s38
s_waitcnt vmcnt(2)
ds_write_b16 v1, v0 offset:96
ds_read_b64_tr_b16 v[58:59], v6 offset:128
ds_read_b64_tr_b16 v[60:61], v6
ds_read_b64_tr_b16 v[62:63], v6 offset:384
ds_read_b64_tr_b16 v[64:65], v6 offset:256
ds_read_b64_tr_b16 v[66:67], v6 offset:640
ds_read_b64_tr_b16 v[68:69], v6 offset:512
ds_read_b64_tr_b16 v[70:71], v6 offset:896
ds_read_b64_tr_b16 v[72:73], v6 offset:768
ds_read_b64_tr_b16 v[74:75], v6 offset:1152
ds_read_b64_tr_b16 v[76:77], v6 offset:1024
ds_read_b64_tr_b16 v[78:79], v6 offset:1408
ds_read_b64_tr_b16 v[80:81], v6 offset:1280
ds_read_b64_tr_b16 v[82:83], v6 offset:1664
ds_read_b64_tr_b16 v[84:85], v6 offset:1536
ds_read_b64_tr_b16 v[86:87], v6 offset:1920
ds_read_b64_tr_b16 v[88:89], v6 offset:1792
ds_read_b64_tr_b16 v[36:37], v6 offset:2176
ds_read_b64_tr_b16 v[38:39], v6 offset:2048
ds_read_b64_tr_b16 v[40:41], v6 offset:2432
ds_read_b64_tr_b16 v[42:43], v6 offset:2304
ds_read_b64_tr_b16 v[44:45], v6 offset:2688
ds_read_b64_tr_b16 v[46:47], v6 offset:2560
ds_read_b64_tr_b16 v[48:49], v6 offset:2944
ds_read_b64_tr_b16 v[50:51], v6 offset:2816
ds_read_b64_tr_b16 v[90:91], v6 offset:3200
ds_read_b64_tr_b16 v[92:93], v6 offset:3072
ds_read_b64_tr_b16 v[18:19], v6 offset:3456
ds_read_b64_tr_b16 v[20:21], v6 offset:3328
ds_read_b64_tr_b16 v[22:23], v6 offset:3712
ds_read_b64_tr_b16 v[24:25], v6 offset:3584
ds_read_b64_tr_b16 v[26:27], v6 offset:3968
ds_read_b64_tr_b16 v[28:29], v6 offset:3840
s_waitcnt vmcnt(1)
ds_read_b64_tr_b16 v[0:1], v215
ds_read_b64_tr_b16 v[2:3], v215 offset:256
s_add_u32 m0, s40, 0x2000
s_add_u32 s47, s41, 0x90000
buffer_load_dwordx4 v52, s[12:15], s47 offen lds
s_add_u32 m0, s40, 0x6000
s_add_u32 s47, s41, 0x90000
buffer_load_dwordx4 v52, s[16:19], s47 offen lds
s_waitcnt lgkmcnt(0)
ds_write_b128 v34, v[0:3]
s_waitcnt lgkmcnt(0)
s_barrier
s_setprio 3
ds_read_b128 v[4:7], v220
ds_read_b64 v[8:9], v221
s_waitcnt lgkmcnt(1)
v_mfma_f32_16x16x32_bf16 v[10:13], v[54:57], v[4:7], 0
s_waitcnt lgkmcnt(0)
v_lshlrev_b32 v14, 16, v8
v_and_b32 v15, 0xffff0000, v8
v_lshlrev_b32 v16, 16, v9
v_and_b32 v17, 0xffff0000, v9
s_nop 2
v_mul_f32 v14, v14, v10
v_mul_f32 v15, v15, v11
v_mul_f32 v16, v16, v12
v_mul_f32 v17, v17, v13
v_cvt_pk_bf16_f32 v0, v14, v15
v_cvt_pk_bf16_f32 v1, v16, v17
ds_write_b64 v221, v[0:1]
ds_read_b64_tr_b16 v[0:1], v214
ds_read_b64_tr_b16 v[2:3], v214 offset:128
ds_read_b64_tr_b16 v[4:5], v214 offset:256
s_waitcnt lgkmcnt(1)
v_mfma_f32_16x16x32_bf16 v[114:117], v[58:61], v[0:3], 0
s_waitcnt lgkmcnt(0)
v_mfma_f32_16x16x32_bf16 v[30:33], v[58:61], v[2:5], 0
v_mfma_f32_16x16x32_bf16 v[94:97], v[62:65], v[0:3], 0
s_setprio 2
v_mfma_f32_16x16x32_bf16 v[98:101], v[62:65], v[2:5], 0
s_nop 2
v_add_f32_dpp v35, v117, v116 wave_shr:1 row_mask:0xf bank_mask:0xf bound_ctrl:0
v_mfma_f32_16x16x32_bf16 v[102:105], v[66:69], v[0:3], 0
v_add_f32_dpp v53, v117, v32 wave_ror:1 row_mask:0x1 bank_mask:0x1
v_add_f32_dpp v118, v35, v115 wave_shr:1 row_mask:0xf bank_mask:0xf bound_ctrl:0
v_mfma_f32_16x16x32_bf16 v[106:109], v[66:69], v[2:5], 0
v_add_f32_dpp v53, v33, v32 wave_shr:1 row_mask:0xf bank_mask:0xf
v_add_f32_dpp v229, v35, v31 wave_ror:1 row_mask:0x1 bank_mask:0x1
v_mfma_f32_16x16x32_bf16 v[110:113], v[70:73], v[0:3], 0
v_add_f32_dpp v230, v118, v114 wave_shr:1 row_mask:0xf bank_mask:0xf bound_ctrl:0
v_add_f32_dpp v229, v53, v31 wave_shr:1 row_mask:0xf bank_mask:0xf
v_mfma_f32_16x16x32_bf16 v[114:117], v[70:73], v[2:5], 0
v_add_f32_dpp v231, v118, v30 wave_ror:1 row_mask:0x1 bank_mask:0x1
v_add_f32_dpp v231, v229, v30 wave_shr:1 row_mask:0xf bank_mask:0xf
v_mfma_f32_16x16x32_bf16 v[118:121], v[74:77], v[0:3], 0
s_setprio 1
v_mfma_f32_16x16x32_bf16 v[122:125], v[74:77], v[2:5], 0
v_mfma_f32_16x16x32_bf16 v[126:129], v[78:81], v[0:3], 0
s_waitcnt vmcnt(2)
ds_read_b64_tr_b16 v[150:151], v215 offset:16384
ds_read_b64_tr_b16 v[152:153], v215 offset:16640
s_add_u32 m0, s40, 0x8000
s_add_u32 s47, s34, 0
buffer_load_dwordx4 v223, s[20:23], s47 offen lds
v_mfma_f32_16x16x32_bf16 v[130:133], v[78:81], v[2:5], 0
v_mfma_f32_16x16x32_bf16 v[134:137], v[82:85], v[0:3], 0
v_mfma_f32_16x16x32_bf16 v[138:141], v[82:85], v[2:5], 0
v_mfma_f32_16x16x32_bf16 v[142:145], v[86:89], v[0:3], 0
v_mfma_f32_16x16x32_bf16 v[146:149], v[86:89], v[2:5], 0
s_waitcnt lgkmcnt(0)
ds_write_b128 v34, v[150:153] offset:512
ds_write_b32 v227, v228
v_mfma_f32_16x16x32_bf16 v[150:153], v[36:39], v[0:3], 0
ds_read_b64_tr_b16 v[6:7], v214 offset:384
s_setprio 0
v_mfma_f32_16x16x32_bf16 v[154:157], v[36:39], v[2:5], 0
ds_read_b64_tr_b16 v[8:9], v214 offset:512
v_mfma_f32_16x16x32_bf16 v[158:161], v[40:43], v[0:3], 0
v_mfma_f32_16x16x32_bf16 v[162:165], v[40:43], v[2:5], 0
v_mfma_f32_16x16x32_bf16 v[166:169], v[44:47], v[0:3], 0
ds_read_b32 v35, v226
v_mfma_f32_16x16x32_bf16 v[170:173], v[44:47], v[2:5], 0
v_mfma_f32_16x16x32_bf16 v[174:177], v[48:51], v[0:3], 0
v_mfma_f32_16x16x32_bf16 v[178:181], v[48:51], v[2:5], 0
v_mfma_f32_16x16x32_bf16 v[182:185], v[90:93], v[0:3], 0
v_mfma_f32_16x16x32_bf16 v[186:189], v[90:93], v[2:5], 0
s_waitcnt lgkmcnt(0)
v_cmp_ne_u32 vcc, 1, v35
s_cbranch_vccnz L_f1r
L_f1:
s_setprio 3
ds_read_b128 v[232:235], v220 offset:512
ds_read_b64 v[236:237], v221 offset:512
v_mfma_f32_16x16x32_bf16 v[190:193], v[18:21], v[0:3], 0
v_mfma_f32_16x16x32_bf16 v[194:197], v[18:21], v[2:5], 0
v_mfma_f32_16x16x32_bf16 v[198:201], v[22:25], v[0:3], 0
v_mfma_f32_16x16x32_bf16 v[202:205], v[22:25], v[2:5], 0
v_mfma_f32_16x16x32_bf16 v[206:209], v[26:29], v[0:3], 0
s_waitcnt lgkmcnt(0)
v_lshlrev_b32 v34, 16, v236
v_and_b32 v238, 0xffff0000, v236
v_mfma_f32_16x16x32_bf16 v[210:213], v[26:29], v[2:5], 0
v_lshlrev_b32 v35, 16, v237
v_and_b32 v239, 0xffff0000, v237
v_mfma_f32_16x16x32_bf16 v[94:97], v[58:61], v[4:7], v[94:97]
s_add_u32 m0, s40, 0
s_add_u32 s47, s41, 0x120000
buffer_load_dwordx4 v52, s[12:15], s47 offen lds
v_mfma_f32_16x16x32_bf16 v[240:243], v[54:57], v[232:235], 0
v_mfma_f32_16x16x32_bf16 v[98:101], v[58:61], v[6:9], v[98:101]
v_mfma_f32_16x16x32_bf16 v[102:105], v[62:65], v[4:7], v[102:105]
v_mfma_f32_16x16x32_bf16 v[106:109], v[62:65], v[6:9], v[106:109]
s_setprio 2
s_nop 3
v_mul_f32 v34, v34, v240
v_mul_f32 v238, v238, v241
v_mfma_f32_16x16x32_bf16 v[110:113], v[66:69], v[4:7], v[110:113]
v_mul_f32 v35, v35, v242
v_mul_f32 v239, v239, v243
v_mfma_f32_16x16x32_bf16 v[114:117], v[66:69], v[6:9], v[114:117]
v_cvt_pk_bf16_f32 v26, v34, v238
v_cvt_pk_bf16_f32 v27, v35, v239
ds_write_b64 v221, v[26:27] offset:512
v_mfma_f32_16x16x32_bf16 v[118:121], v[70:73], v[4:7], v[118:121]
v_add_f32_dpp v28, v33, v96 wave_ror:1 row_mask:0x1 bank_mask:0x1
v_add_f32_dpp v29, v53, v95 wave_ror:1 row_mask:0x1 bank_mask:0x1
v_mfma_f32_16x16x32_bf16 v[122:125], v[70:73], v[6:9], v[122:125]
v_add_f32_dpp v28, v97, v96 wave_shr:1 row_mask:0xf bank_mask:0xf
v_add_f32_dpp v232, v229, v94 wave_ror:1 row_mask:0x1 bank_mask:0x1
v_mfma_f32_16x16x32_bf16 v[126:129], v[74:77], v[4:7], v[126:129]
v_add_f32_dpp v233, v97, v100 wave_ror:1 row_mask:0x1 bank_mask:0x1
v_add_f32_dpp v29, v28, v95 wave_shr:1 row_mask:0xf bank_mask:0xf
v_mfma_f32_16x16x32_bf16 v[130:133], v[74:77], v[6:9], v[130:133]
v_add_f32_dpp v233, v101, v100 wave_shr:1 row_mask:0xf bank_mask:0xf
v_add_f32_dpp v34, v28, v99 wave_ror:1 row_mask:0x1 bank_mask:0x1
v_mfma_f32_16x16x32_bf16 v[134:137], v[78:81], v[4:7], v[134:137]
s_setprio 1
v_add_f32_dpp v232, v29, v94 wave_shr:1 row_mask:0xf bank_mask:0xf
v_add_f32_dpp v34, v233, v99 wave_shr:1 row_mask:0xf bank_mask:0xf
v_mfma_f32_16x16x32_bf16 v[138:141], v[78:81], v[6:9], v[138:141]
v_add_f32_dpp v53, v29, v98 wave_ror:1 row_mask:0x1 bank_mask:0x1
v_add_f32_dpp v53, v34, v98 wave_shr:1 row_mask:0xf bank_mask:0xf
v_mfma_f32_16x16x32_bf16 v[142:145], v[82:85], v[4:7], v[142:145]
v_mfma_f32_16x16x32_bf16 v[146:149], v[82:85], v[6:9], v[146:149]
v_mfma_f32_16x16x32_bf16 v[150:153], v[86:89], v[4:7], v[150:153]
s_waitcnt vmcnt(3)
ds_read_b64_tr_b16 v[30:31], v215 offset:8192
ds_read_b64_tr_b16 v[32:33], v215 offset:8448
v_mfma_f32_16x16x32_bf16 v[154:157], v[86:89], v[6:9], v[154:157]
ds_read_b64_tr_b16 v[10:11], v214 offset:640
ds_read_b64_tr_b16 v[12:13], v214 offset:768
v_mfma_f32_16x16x32_bf16 v[158:161], v[36:39], v[4:7], v[158:161]
v_mfma_f32_16x16x32_bf16 v[162:165], v[36:39], v[6:9], v[162:165]
s_waitcnt vmcnt(2)
ds_read_b64_tr_b16 v[26:27], v215 offset:24576
ds_read_b64_tr_b16 v[28:29], v215 offset:24832
v_mfma_f32_16x16x32_bf16 v[166:169], v[40:43], v[4:7], v[166:169]
v_mfma_f32_16x16x32_bf16 v[170:173], v[40:43], v[6:9], v[170:173]
s_waitcnt lgkmcnt(2)
ds_write_b128 v217, v[30:33] offset:1024
v_mfma_f32_16x16x32_bf16 v[174:177], v[44:47], v[4:7], v[174:177]
s_setprio 0
v_mfma_f32_16x16x32_bf16 v[178:181], v[44:47], v[6:9], v[178:181]
v_mfma_f32_16x16x32_bf16 v[182:185], v[48:51], v[4:7], v[182:185]
s_add_u32 m0, s40, 0x4000
s_add_u32 s47, s41, 0x120000
buffer_load_dwordx4 v52, s[16:19], s47 offen lds
s_waitcnt lgkmcnt(1)
ds_write_b128 v216, v[26:29] offset:1024
ds_write_b32 v227, v228 offset:32
v_mfma_f32_16x16x32_bf16 v[186:189], v[48:51], v[6:9], v[186:189]
v_mfma_f32_16x16x32_bf16 v[190:193], v[90:93], v[4:7], v[190:193]
v_mfma_f32_16x16x32_bf16 v[194:197], v[90:93], v[6:9], v[194:197]
v_mfma_f32_16x16x32_bf16 v[198:201], v[18:21], v[4:7], v[198:201]
v_mfma_f32_16x16x32_bf16 v[202:205], v[18:21], v[6:9], v[202:205]
ds_read_b32 v30, v226 offset:32
v_mfma_f32_16x16x32_bf16 v[206:209], v[22:25], v[4:7], v[206:209]
v_mfma_f32_16x16x32_bf16 v[210:213], v[22:25], v[6:9], v[210:213]
v_mfma_f32_16x16x32_bf16 v[102:105], v[58:61], v[8:11], v[102:105]
v_mfma_f32_16x16x32_bf16 v[106:109], v[58:61], v[10:13], v[106:109]
v_mfma_f32_16x16x32_bf16 v[206:209], v[18:21], v[8:11], v[206:209]
s_waitcnt lgkmcnt(0)
v_cmp_ne_u32 vcc, 1, v30
s_cbranch_vccnz L_f2r
L_f2:
s_setprio 3
ds_read_b128 v[26:29], v220 offset:1024
ds_read_b64 v[32:33], v221 offset:1024
v_mfma_f32_16x16x32_bf16 v[210:213], v[18:21], v[10:13], v[210:213]
ds_read_b64_tr_b16 v[14:15], v214 offset:896
ds_read_b64_tr_b16 v[16:17], v214 offset:1024
v_add_f32_dpp v31, v101, v104 wave_ror:1 row_mask:0x1 bank_mask:0x1
v_add_f32_dpp v22, v233, v103 wave_ror:1 row_mask:0x1 bank_mask:0x1
v_mfma_f32_16x16x32_bf16 v[198:201], v[90:93], v[8:11], v[198:201]
v_add_f32_dpp v31, v105, v104 wave_shr:1 row_mask:0xf bank_mask:0xf
v_add_f32_dpp v94, v34, v102 wave_ror:1 row_mask:0x1 bank_mask:0x1
v_mfma_f32_16x16x32_bf16 v[202:205], v[90:93], v[10:13], v[202:205]
v_add_f32_dpp v95, v105, v108 wave_ror:1 row_mask:0x1 bank_mask:0x1
v_add_f32_dpp v22, v31, v103 wave_shr:1 row_mask:0xf bank_mask:0xf
v_mfma_f32_16x16x32_bf16 v[190:193], v[48:51], v[8:11], v[190:193]
v_add_f32_dpp v95, v109, v108 wave_shr:1 row_mask:0xf bank_mask:0xf
v_add_f32_dpp v96, v31, v107 wave_ror:1 row_mask:0x1 bank_mask:0x1
v_mfma_f32_16x16x32_bf16 v[194:197], v[48:51], v[10:13], v[194:197]
s_waitcnt lgkmcnt(0)
v_lshlrev_b32 v18, 16, v32
v_and_b32 v19, 0xffff0000, v32
v_mfma_f32_16x16x32_bf16 v[182:185], v[44:47], v[8:11], v[182:185]
v_lshlrev_b32 v20, 16, v33
v_and_b32 v21, 0xffff0000, v33
v_mfma_f32_16x16x32_bf16 v[186:189], v[44:47], v[10:13], v[186:189]
v_mfma_f32_16x16x32_bf16 v[98:101], v[54:57], v[26:29], 0
v_mfma_f32_16x16x32_bf16 v[174:177], v[40:43], v[8:11], v[174:177]
v_add_f32_dpp v94, v22, v102 wave_shr:1 row_mask:0xf bank_mask:0xf
v_add_f32_dpp v96, v95, v107 wave_shr:1 row_mask:0xf bank_mask:0xf
v_mfma_f32_16x16x32_bf16 v[178:181], v[40:43], v[10:13], v[178:181]
v_add_f32_dpp v97, v22, v106 wave_ror:1 row_mask:0x1 bank_mask:0x1
v_add_f32_dpp v97, v96, v106 wave_shr:1 row_mask:0xf bank_mask:0xf
v_mfma_f32_16x16x32_bf16 v[166:169], v[36:39], v[8:11], v[166:169]
s_nop 0
v_mul_f32 v18, v18, v98
v_mul_f32 v19, v19, v99
v_mfma_f32_16x16x32_bf16 v[170:173], v[36:39], v[10:13], v[170:173]
v_mul_f32 v20, v20, v100
v_mul_f32 v21, v21, v101
v_mfma_f32_16x16x32_bf16 v[158:161], v[86:89], v[8:11], v[158:161]
s_add_u32 m0, s40, 0xa000
s_add_u32 s47, s34, 0x90000
buffer_load_dwordx4 v223, s[20:23], s47 offen lds
v_cvt_pk_bf16_f32 v24, v18, v19
v_cvt_pk_bf16_f32 v25, v20, v21
ds_write_b64 v221, v[24:25] offset:1024
v_mfma_f32_16x16x32_bf16 v[162:165], v[86:89], v[10:13], v[162:165]
v_mfma_f32_16x16x32_bf16 v[110:113], v[62:65], v[8:11], v[110:113]
v_mfma_f32_16x16x32_bf16 v[114:117], v[62:65], v[10:13], v[114:117]
v_mfma_f32_16x16x32_bf16 v[110:113], v[58:61], v[12:15], v[110:113]
v_mfma_f32_16x16x32_bf16 v[114:117], v[58:61], v[14:17], v[114:117]
v_mfma_f32_16x16x32_bf16 v[206:209], v[90:93], v[12:15], v[206:209]
s_setprio 2
ds_read_b64_tr_b16 v[18:19], v214 offset:1024
ds_read_b64_tr_b16 v[20:21], v214 offset:1152
v_mfma_f32_16x16x32_bf16 v[210:213], v[90:93], v[14:17], v[210:213]
ds_read_b64_tr_b16 v[22:23], v214 offset:1280
s_nop 0
v_add_f32_dpp v98, v109, v112 wave_ror:1 row_mask:0x1 bank_mask:0x1
v_add_f32_dpp v99, v95, v111 wave_ror:1 row_mask:0x1 bank_mask:0x1
v_mfma_f32_16x16x32_bf16 v[198:201], v[48:51], v[12:15], v[198:201]
v_add_f32_dpp v98, v113, v112 wave_shr:1 row_mask:0xf bank_mask:0xf
v_add_f32_dpp v100, v96, v110 wave_ror:1 row_mask:0x1 bank_mask:0x1
v_mfma_f32_16x16x32_bf16 v[202:205], v[48:51], v[14:17], v[202:205]
v_add_f32_dpp v101, v113, v116 wave_ror:1 row_mask:0x1 bank_mask:0x1
v_add_f32_dpp v99, v98, v111 wave_shr:1 row_mask:0xf bank_mask:0xf
v_mfma_f32_16x16x32_bf16 v[190:193], v[44:47], v[12:15], v[190:193]
v_add_f32_dpp v101, v117, v116 wave_shr:1 row_mask:0xf bank_mask:0xf
v_add_f32_dpp v102, v98, v115 wave_ror:1 row_mask:0x1 bank_mask:0x1
v_mfma_f32_16x16x32_bf16 v[194:197], v[44:47], v[14:17], v[194:197]
v_add_f32_dpp v100, v99, v110 wave_shr:1 row_mask:0xf bank_mask:0xf
v_add_f32_dpp v102, v101, v115 wave_shr:1 row_mask:0xf bank_mask:0xf
v_mfma_f32_16x16x32_bf16 v[182:185], v[40:43], v[12:15], v[182:185]
v_add_f32_dpp v95, v99, v114 wave_ror:1 row_mask:0x1 bank_mask:0x1
v_add_f32_dpp v95, v102, v114 wave_shr:1 row_mask:0xf bank_mask:0xf
v_mfma_f32_16x16x32_bf16 v[186:189], v[40:43], v[14:17], v[186:189]
v_mfma_f32_16x16x32_bf16 v[174:177], v[36:39], v[12:15], v[174:177]
v_mfma_f32_16x16x32_bf16 v[178:181], v[36:39], v[14:17], v[178:181]
v_mfma_f32_16x16x32_bf16 v[166:169], v[86:89], v[12:15], v[166:169]
v_mfma_f32_16x16x32_bf16 v[170:173], v[86:89], v[14:17], v[170:173]
v_mfma_f32_16x16x32_bf16 v[118:121], v[66:69], v[8:11], v[118:121]
ds_read_b128 v[90:93], v220 offset:1536
ds_read_b64 v[104:105], v221 offset:1536
v_mfma_f32_16x16x32_bf16 v[122:125], v[66:69], v[10:13], v[122:125]
v_mfma_f32_16x16x32_bf16 v[118:121], v[62:65], v[12:15], v[118:121]
v_mfma_f32_16x16x32_bf16 v[122:125], v[62:65], v[14:17], v[122:125]
s_waitcnt lgkmcnt(2)
v_mfma_f32_16x16x32_bf16 v[118:121], v[58:61], v[18:21], v[118:121]
s_add_u32 m0, s40, 0x2000
s_add_u32 s47, s41, 0x1b0000
buffer_load_dwordx4 v52, s[12:15], s47 offen lds
v_mfma_f32_16x16x32_bf16 v[122:125], v[58:61], v[20:23], v[122:125]
s_waitcnt lgkmcnt(0)
v_lshlrev_b32 v96, 16, v104
v_and_b32 v98, 0xffff0000, v104
v_mfma_f32_16x16x32_bf16 v[206:209], v[48:51], v[18:21], v[206:209]
v_lshlrev_b32 v99, 16, v105
v_and_b32 v103, 0xffff0000, v105
ds_read_b64_tr_b16 v[24:25], v214 offset:1408
v_mfma_f32_16x16x32_bf16 v[210:213], v[48:51], v[20:23], v[210:213]
v_mfma_f32_16x16x32_bf16 v[106:109], v[54:57], v[90:93], 0
ds_read_b64_tr_b16 v[26:27], v214 offset:1536
v_mfma_f32_16x16x32_bf16 v[198:201], v[44:47], v[18:21], v[198:201]
v_add_f32_dpp v110, v117, v120 wave_ror:1 row_mask:0x1 bank_mask:0x1
s_setprio 1
v_add_f32_dpp v111, v101, v119 wave_ror:1 row_mask:0x1 bank_mask:0x1
v_mfma_f32_16x16x32_bf16 v[202:205], v[44:47], v[20:23], v[202:205]
v_add_f32_dpp v110, v121, v120 wave_shr:1 row_mask:0xf bank_mask:0xf
v_add_f32_dpp v112, v102, v118 wave_ror:1 row_mask:0x1 bank_mask:0x1
v_mfma_f32_16x16x32_bf16 v[190:193], v[40:43], v[18:21], v[190:193]
v_mul_f32 v96, v96, v106
v_mul_f32 v98, v98, v107
v_mfma_f32_16x16x32_bf16 v[194:197], v[40:43], v[20:23], v[194:197]
v_mul_f32 v99, v99, v108
v_mul_f32 v103, v103, v109
v_mfma_f32_16x16x32_bf16 v[182:185], v[36:39], v[18:21], v[182:185]
v_cvt_pk_bf16_f32 v48, v96, v98
v_cvt_pk_bf16_f32 v49, v99, v103
ds_write_b64 v221, v[48:49] offset:1536
v_mfma_f32_16x16x32_bf16 v[186:189], v[36:39], v[20:23], v[186:189]
v_add_f32_dpp v50, v121, v124 wave_ror:1 row_mask:0x1 bank_mask:0x1
v_add_f32_dpp v111, v110, v119 wave_shr:1 row_mask:0xf bank_mask:0xf
v_mfma_f32_16x16x32_bf16 v[174:177], v[86:89], v[18:21], v[174:177]
v_add_f32_dpp v50, v125, v124 wave_shr:1 row_mask:0xf bank_mask:0xf
v_add_f32_dpp v51, v110, v123 wave_ror:1 row_mask:0x1 bank_mask:0x1
v_mfma_f32_16x16x32_bf16 v[178:181], v[86:89], v[20:23], v[178:181]
v_add_f32_dpp v112, v111, v118 wave_shr:1 row_mask:0xf bank_mask:0xf
v_add_f32_dpp v51, v50, v123 wave_shr:1 row_mask:0xf bank_mask:0xf
v_mfma_f32_16x16x32_bf16 v[126:129], v[70:73], v[8:11], v[126:129]
v_add_f32_dpp v96, v111, v122 wave_ror:1 row_mask:0x1 bank_mask:0x1
v_add_f32_dpp v96, v51, v122 wave_shr:1 row_mask:0xf bank_mask:0xf
v_mfma_f32_16x16x32_bf16 v[130:133], v[70:73], v[10:13], v[130:133]
v_mfma_f32_16x16x32_bf16 v[126:129], v[66:69], v[12:15], v[126:129]
v_mfma_f32_16x16x32_bf16 v[130:133], v[66:69], v[14:17], v[130:133]
v_mfma_f32_16x16x32_bf16 v[126:129], v[62:65], v[18:21], v[126:129]
v_mfma_f32_16x16x32_bf16 v[130:133], v[62:65], v[20:23], v[130:133]
s_waitcnt lgkmcnt(0)
v_mfma_f32_16x16x32_bf16 v[126:129], v[58:61], v[22:25], v[126:129]
s_add_u32 m0, s40, 0x6000
s_add_u32 s47, s41, 0x1b0000
buffer_load_dwordx4 v52, s[16:19], s47 offen lds
v_mfma_f32_16x16x32_bf16 v[130:133], v[58:61], v[24:27], v[130:133]
v_mfma_f32_16x16x32_bf16 v[206:209], v[44:47], v[22:25], v[206:209]
s_waitcnt vmcnt(4)
ds_read_b64_tr_b16 v[90:91], v215
ds_read_b64_tr_b16 v[92:93], v215 offset:256
v_mfma_f32_16x16x32_bf16 v[210:213], v[44:47], v[24:27], v[210:213]
ds_read_b64_tr_b16 v[28:29], v214 offset:1664
ds_read_b64_tr_b16 v[30:31], v214 offset:1792
v_add_f32_dpp v48, v125, v128 wave_ror:1 row_mask:0x1 bank_mask:0x1
v_add_f32_dpp v49, v50, v127 wave_ror:1 row_mask:0x1 bank_mask:0x1
v_mfma_f32_16x16x32_bf16 v[198:201], v[40:43], v[22:25], v[198:201]
v_add_f32_dpp v48, v129, v128 wave_shr:1 row_mask:0xf bank_mask:0xf
v_add_f32_dpp v98, v51, v126 wave_ror:1 row_mask:0x1 bank_mask:0x1
v_mfma_f32_16x16x32_bf16 v[202:205], v[40:43], v[24:27], v[202:205]
s_setprio 0
s_waitcnt vmcnt(3)
ds_read_b64_tr_b16 v[102:103], v215 offset:16384
ds_read_b64_tr_b16 v[104:105], v215 offset:16640
v_add_f32_dpp v44, v129, v132 wave_ror:1 row_mask:0x1 bank_mask:0x1
v_add_f32_dpp v49, v48, v127 wave_shr:1 row_mask:0xf bank_mask:0xf
v_mfma_f32_16x16x32_bf16 v[190:193], v[36:39], v[22:25], v[190:193]
v_add_f32_dpp v44, v133, v132 wave_shr:1 row_mask:0xf bank_mask:0xf
v_add_f32_dpp v45, v48, v131 wave_ror:1 row_mask:0x1 bank_mask:0x1
v_mfma_f32_16x16x32_bf16 v[194:197], v[36:39], v[24:27], v[194:197]
s_waitcnt lgkmcnt(2)
ds_write_b128 v217, v[90:93] offset:2048
v_add_f32_dpp v98, v49, v126 wave_shr:1 row_mask:0xf bank_mask:0xf
v_add_f32_dpp v45, v44, v131 wave_shr:1 row_mask:0xf bank_mask:0xf
v_mfma_f32_16x16x32_bf16 v[182:185], v[86:89], v[22:25], v[182:185]
ds_read_b64_tr_b16 v[106:107], v215 offset:32768
ds_read_b64_tr_b16 v[108:109], v215 offset:33024
v_add_f32_dpp v99, v49, v130 wave_ror:1 row_mask:0x1 bank_mask:0x1
v_add_f32_dpp v99, v45, v130 wave_shr:1 row_mask:0xf bank_mask:0xf
v_mfma_f32_16x16x32_bf16 v[186:189], v[86:89], v[24:27], v[186:189]
s_waitcnt vmcnt(2)
ds_read_b64_tr_b16 v[114:115], v215 offset:40960
ds_read_b64_tr_b16 v[116:117], v215 offset:41216
v_mfma_f32_16x16x32_bf16 v[134:137], v[74:77], v[8:11], v[134:137]
s_waitcnt lgkmcnt(5)
ds_write_b128 v216, v[102:105] offset:2048
v_mfma_f32_16x16x32_bf16 v[138:141], v[74:77], v[10:13], v[138:141]
v_mfma_f32_16x16x32_bf16 v[134:137], v[70:73], v[12:15], v[134:137]
v_mfma_f32_16x16x32_bf16 v[138:141], v[70:73], v[14:17], v[138:141]
s_waitcnt lgkmcnt(1)
ds_write_b128 v218, v[106:109]
v_mfma_f32_16x16x32_bf16 v[134:137], v[66:69], v[18:21], v[134:137]
ds_write_b128 v218, v[114:117] offset:1024
ds_write_b32 v227, v228 offset:64
v_mfma_f32_16x16x32_bf16 v[138:141], v[66:69], v[20:23], v[138:141]
v_mfma_f32_16x16x32_bf16 v[134:137], v[62:65], v[22:25], v[134:137]
v_mfma_f32_16x16x32_bf16 v[138:141], v[62:65], v[24:27], v[138:141]
v_mfma_f32_16x16x32_bf16 v[134:137], v[58:61], v[26:29], v[134:137]
s_add_u32 m0, s40, 0x8000
s_add_u32 s47, s34, 0x120000
buffer_load_dwordx4 v223, s[20:23], s47 offen lds
v_mfma_f32_16x16x32_bf16 v[138:141], v[58:61], v[28:31], v[138:141]
ds_read_b32 v46, v226 offset:64
v_mfma_f32_16x16x32_bf16 v[206:209], v[40:43], v[26:29], v[206:209]
ds_read_b64_tr_b16 v[32:33], v214 offset:1920
v_mfma_f32_16x16x32_bf16 v[210:213], v[40:43], v[28:31], v[210:213]
ds_read_b64_tr_b16 v[34:35], v214 offset:2048
v_add_f32_dpp v47, v133, v136 wave_ror:1 row_mask:0x1 bank_mask:0x1
v_add_f32_dpp v48, v44, v135 wave_ror:1 row_mask:0x1 bank_mask:0x1
v_mfma_f32_16x16x32_bf16 v[198:201], v[36:39], v[26:29], v[198:201]
v_add_f32_dpp v47, v137, v136 wave_shr:1 row_mask:0xf bank_mask:0xf
v_add_f32_dpp v101, v45, v134 wave_ror:1 row_mask:0x1 bank_mask:0x1
v_mfma_f32_16x16x32_bf16 v[202:205], v[36:39], v[28:31], v[202:205]
v_add_f32_dpp v102, v137, v140 wave_ror:1 row_mask:0x1 bank_mask:0x1
v_add_f32_dpp v48, v47, v135 wave_shr:1 row_mask:0xf bank_mask:0xf
v_mfma_f32_16x16x32_bf16 v[190:193], v[86:89], v[26:29], v[190:193]
s_waitcnt lgkmcnt(1)
v_cmp_ne_u32 vcc, 1, v46
s_cbranch_vccnz L_f3r
L_f3:
s_setprio 3
ds_read_b32 v40, v219
ds_read_b32 v41, v219 offset:256
v_mfma_f32_16x16x32_bf16 v[194:197], v[86:89], v[28:31], v[194:197]
ds_read_b32 v42, v219 offset:512
ds_read_b32 v43, v219 offset:768
v_add_f32_dpp v102, v141, v140 wave_shr:1 row_mask:0xf bank_mask:0xf
v_add_f32_dpp v103, v47, v139 wave_ror:1 row_mask:0x1 bank_mask:0x1
v_mfma_f32_16x16x32_bf16 v[142:145], v[78:81], v[8:11], v[142:145]
ds_read_b32 v104, v219 offset:1024
ds_read_b128 v[90:93], v220 offset:2048
v_add_f32_dpp v101, v48, v134 wave_shr:1 row_mask:0xf bank_mask:0xf
v_add_f32_dpp v103, v102, v139 wave_shr:1 row_mask:0xf bank_mask:0xf
v_mfma_f32_16x16x32_bf16 v[146:149], v[78:81], v[10:13], v[146:149]
ds_read_b64 v[106:107], v221 offset:2048
ds_read_b32 v105, v219 offset:1280
v_add_f32_dpp v108, v48, v138 wave_ror:1 row_mask:0x1 bank_mask:0x1
v_add_f32_dpp v108, v103, v138 wave_shr:1 row_mask:0xf bank_mask:0xf
v_mfma_f32_16x16x32_bf16 v[142:145], v[74:77], v[12:15], v[142:145]
ds_read_b32 v109, v219 offset:1536
v_mfma_f32_16x16x32_bf16 v[146:149], v[74:77], v[14:17], v[146:149]
s_waitcnt lgkmcnt(5)
v_lshlrev_b32 v44, 16, v40
v_and_b32 v40, 0xffff0000, v40
v_mfma_f32_16x16x32_bf16 v[142:145], v[70:73], v[18:21], v[142:145]
v_mul_f32 v44, v44, v230
v_mul_f32 v40, v40, v231
v_mfma_f32_16x16x32_bf16 v[146:149], v[70:73], v[20:23], v[146:149]
s_mov_b32 m0, s38
v_cvt_pk_bf16_f32 v45, v44, v40
ds_write_addtid_b32 v45
v_lshlrev_b32 v46, 16, v41
v_mfma_f32_16x16x32_bf16 v[142:145], v[66:69], v[22:25], v[142:145]
v_and_b32 v41, 0xffff0000, v41
v_mul_f32 v46, v46, v232
s_setprio 2
v_mfma_f32_16x16x32_bf16 v[146:149], v[66:69], v[24:27], v[146:149]
v_mul_f32 v41, v41, v53
v_cvt_pk_bf16_f32 v47, v46, v41
ds_write_addtid_b32 v47 offset:256
v_mfma_f32_16x16x32_bf16 v[142:145], v[62:65], v[26:29], v[142:145]
v_lshlrev_b32 v48, 16, v42
v_and_b32 v42, 0xffff0000, v42
v_mfma_f32_16x16x32_bf16 v[146:149], v[62:65], v[28:31], v[146:149]
v_mul_f32 v48, v48, v94
v_mul_f32 v42, v42, v97
v_mfma_f32_16x16x32_bf16 v[142:145], v[58:61], v[30:33], v[142:145]
v_cvt_pk_bf16_f32 v40, v48, v42
ds_write_addtid_b32 v40 offset:512
v_lshlrev_b32 v44, 16, v43
v_mfma_f32_16x16x32_bf16 v[146:149], v[58:61], v[32:35], v[146:149]
v_and_b32 v43, 0xffff0000, v43
v_mul_f32 v44, v44, v100
ds_read_b32 v110, v219 offset:1792
v_mfma_f32_16x16x32_bf16 v[206:209], v[36:39], v[30:33], v[206:209]
v_mul_f32 v43, v43, v95
v_cvt_pk_bf16_f32 v41, v44, v43
ds_write_addtid_b32 v41 offset:768
ds_write_b32 v227, v228 offset:192
v_mfma_f32_16x16x32_bf16 v[210:213], v[36:39], v[32:35], v[210:213]
s_waitcnt lgkmcnt(4)
v_lshlrev_b32 v94, 16, v104
v_and_b32 v104, 0xffff0000, v104
ds_read_b64_tr_b16 v[36:37], v214 offset:2048
v_mfma_f32_16x16x32_bf16 v[198:201], v[86:89], v[30:33], v[198:201]
v_mul_f32 v94, v94, v112
v_mul_f32 v104, v104, v96
s_setprio 1
v_mfma_f32_16x16x32_bf16 v[202:205], v[86:89], v[32:35], v[202:205]
v_cvt_pk_bf16_f32 v95, v94, v104
ds_write_addtid_b32 v95 offset:1024
v_lshlrev_b32 v100, 16, v106
v_mfma_f32_16x16x32_bf16 v[150:153], v[82:85], v[8:11], v[150:153]
v_and_b32 v111, 0xffff0000, v106
v_lshlrev_b32 v113, 16, v107
v_mfma_f32_16x16x32_bf16 v[154:157], v[82:85], v[10:13], v[154:157]
v_and_b32 v114, 0xffff0000, v107
v_lshlrev_b32 v115, 16, v105
ds_read_b32 v112, v226 offset:192
v_mfma_f32_16x16x32_bf16 v[150:153], v[78:81], v[12:15], v[150:153]
v_mfma_f32_16x16x32_bf16 v[116:119], v[54:57], v[90:93], 0
ds_read_b128 v[94:97], v220 offset:2560
ds_read_b64 v[120:121], v221 offset:2560
v_mfma_f32_16x16x32_bf16 v[154:157], v[78:81], v[14:17], v[154:157]
v_and_b32 v105, 0xffff0000, v105
v_mul_f32 v115, v115, v98
v_mfma_f32_16x16x32_bf16 v[150:153], v[74:77], v[18:21], v[150:153]
v_mul_f32 v105, v105, v99
v_cvt_pk_bf16_f32 v104, v115, v105
ds_write_addtid_b32 v104 offset:1280
v_mfma_f32_16x16x32_bf16 v[154:157], v[74:77], v[20:23], v[154:157]
v_mul_f32 v100, v100, v116
v_mul_f32 v111, v111, v117
v_mfma_f32_16x16x32_bf16 v[150:153], v[70:73], v[22:25], v[150:153]
v_mul_f32 v113, v113, v118
v_mul_f32 v114, v114, v119
v_mfma_f32_16x16x32_bf16 v[154:157], v[70:73], v[24:27], v[154:157]
s_setprio 0
v_cvt_pk_bf16_f32 v90, v100, v111
v_cvt_pk_bf16_f32 v91, v113, v114
ds_write_b64 v221, v[90:91] offset:2048
ds_read_b64_tr_b16 v[38:39], v214 offset:2176
v_mfma_f32_16x16x32_bf16 v[150:153], v[66:69], v[26:29], v[150:153]
ds_read_b64_tr_b16 v[40:41], v214 offset:2304
v_add_f32_dpp v92, v141, v144 wave_ror:1 row_mask:0x1 bank_mask:0x1
v_add_f32_dpp v93, v102, v143 wave_ror:1 row_mask:0x1 bank_mask:0x1
v_mfma_f32_16x16x32_bf16 v[154:157], v[66:69], v[28:31], v[154:157]
v_add_f32_dpp v92, v145, v144 wave_shr:1 row_mask:0xf bank_mask:0xf
v_add_f32_dpp v98, v103, v142 wave_ror:1 row_mask:0x1 bank_mask:0x1
v_mfma_f32_16x16x32_bf16 v[150:153], v[62:65], v[30:33], v[150:153]
v_add_f32_dpp v99, v145, v148 wave_ror:1 row_mask:0x1 bank_mask:0x1
v_add_f32_dpp v93, v92, v143 wave_shr:1 row_mask:0xf bank_mask:0xf
v_mfma_f32_16x16x32_bf16 v[154:157], v[62:65], v[32:35], v[154:157]
v_add_f32_dpp v99, v149, v148 wave_shr:1 row_mask:0xf bank_mask:0xf
v_add_f32_dpp v90, v92, v147 wave_ror:1 row_mask:0x1 bank_mask:0x1
s_waitcnt lgkmcnt(1)
v_mfma_f32_16x16x32_bf16 v[150:153], v[58:61], v[36:39], v[150:153]
v_add_f32_dpp v98, v93, v142 wave_shr:1 row_mask:0xf bank_mask:0xf
v_add_f32_dpp v90, v99, v147 wave_shr:1 row_mask:0xf bank_mask:0xf
s_add_u32 m0, s40, 0xa000
s_add_u32 s47, s34, 0x1b0000
buffer_load_dwordx4 v223, s[20:23], s47 offen lds
ds_read_b64_tr_b16 v[42:43], v214 offset:2432
s_waitcnt lgkmcnt(1)
v_mfma_f32_16x16x32_bf16 v[154:157], v[58:61], v[38:41], v[154:157]
v_add_f32_dpp v91, v93, v146 wave_ror:1 row_mask:0x1 bank_mask:0x1
v_add_f32_dpp v91, v90, v146 wave_shr:1 row_mask:0xf bank_mask:0xf
ds_read_b64_tr_b16 v[44:45], v214 offset:2560
v_mfma_f32_16x16x32_bf16 v[206:209], v[86:89], v[36:39], v[206:209]
v_cmp_ne_u32 vcc, 1, v112
s_cbranch_vccnz L_f7r
L_f7:
s_setprio 3
s_waitcnt vmcnt(3)
ds_read_b64_tr_b16 v[102:103], v215 offset:8192
ds_read_b64_tr_b16 v[104:105], v215 offset:8448
v_mfma_f32_16x16x32_bf16 v[210:213], v[86:89], v[38:41], v[210:213]
v_lshlrev_b32 v92, 16, v120
v_and_b32 v100, 0xffff0000, v120
ds_read_b64_tr_b16 v[114:115], v224
ds_read_b64_tr_b16 v[116:117], v224 offset:17152
v_mfma_f32_16x16x32_bf16 v[158:161], v[82:85], v[12:15], v[158:161]
v_lshlrev_b32 v93, 16, v121
v_and_b32 v106, 0xffff0000, v121
s_add_u32 s48, s36, 0
v_mfma_f32_16x16x32_bf16 v[162:165], v[82:85], v[14:17], v[162:165]
s_waitcnt vmcnt(2)
ds_read_b64_tr_b16 v[122:123], v215 offset:24576
ds_read_b64_tr_b16 v[124:125], v215 offset:24832
v_mfma_f32_16x16x32_bf16 v[86:89], v[54:57], v[94:97], 0
v_mfma_f32_16x16x32_bf16 v[158:161], v[78:81], v[18:21], v[158:161]
v_lshlrev_b32 v107, 16, v109
v_and_b32 v109, 0xffff0000, v109
v_mfma_f32_16x16x32_bf16 v[162:165], v[78:81], v[20:23], v[162:165]
s_waitcnt lgkmcnt(2)
ds_write_b128 v217, v[102:105] offset:3072
v_mul_f32 v107, v107, v101
v_mul_f32 v109, v109, v108
s_setprio 2
v_mfma_f32_16x16x32_bf16 v[158:161], v[74:77], v[22:25], v[158:161]
s_waitcnt vmcnt(1)
ds_read_b64_tr_b16 v[0:1], v215 offset:32768
ds_read_b64_tr_b16 v[2:3], v215 offset:33024
v_mul_f32 v92, v92, v86
v_mul_f32 v100, v100, v87
v_mfma_f32_16x16x32_bf16 v[162:165], v[74:77], v[24:27], v[162:165]
v_mul_f32 v93, v93, v88
v_mul_f32 v106, v106, v89
buffer_store_dwordx4 v[114:117], v222, s[24:27], s48 offen
v_mfma_f32_16x16x32_bf16 v[158:161], v[70:73], v[26:29], v[158:161]
s_waitcnt lgkmcnt(3)
ds_write_b128 v216, v[122:125] offset:3072
v_cvt_pk_bf16_f32 v4, v92, v100
v_cvt_pk_bf16_f32 v5, v93, v106
ds_write_b64 v221, v[4:5] offset:2560
v_mfma_f32_16x16x32_bf16 v[162:165], v[70:73], v[28:31], v[162:165]
s_mov_b32 m0, s38
v_cvt_pk_bf16_f32 v6, v107, v109
ds_write_addtid_b32 v6 offset:1536
v_lshlrev_b32 v7, 16, v110
v_mfma_f32_16x16x32_bf16 v[158:161], v[66:69], v[30:33], v[158:161]
v_and_b32 v110, 0xffff0000, v110
v_mul_f32 v7, v7, v98
v_mfma_f32_16x16x32_bf16 v[162:165], v[66:69], v[32:35], v[162:165]
s_setprio 1
s_waitcnt lgkmcnt(3)
ds_write_b128 v218, v[0:3] offset:2048
v_mul_f32 v110, v110, v91
v_cvt_pk_bf16_f32 v4, v7, v110
ds_write_addtid_b32 v4 offset:1792
v_mfma_f32_16x16x32_bf16 v[158:161], v[62:65], v[36:39], v[158:161]
ds_write_b32 v227, v228 offset:96
v_add_f32_dpp v5, v149, v152 wave_ror:1 row_mask:0x1 bank_mask:0x1
v_add_f32_dpp v6, v99, v151 wave_ror:1 row_mask:0x1 bank_mask:0x1
ds_read_b64_tr_b16 v[46:47], v214 offset:2688
v_mfma_f32_16x16x32_bf16 v[162:165], v[62:65], v[38:41], v[162:165]
v_add_f32_dpp v5, v153, v152 wave_shr:1 row_mask:0xf bank_mask:0xf
v_add_f32_dpp v8, v90, v150 wave_ror:1 row_mask:0x1 bank_mask:0x1
ds_read_b64_tr_b16 v[48:49], v214 offset:2816
v_mfma_f32_16x16x32_bf16 v[158:161], v[58:61], v[40:43], v[158:161]
v_add_f32_dpp v0, v153, v156 wave_ror:1 row_mask:0x1 bank_mask:0x1
v_add_f32_dpp v6, v5, v151 wave_shr:1 row_mask:0xf bank_mask:0xf
v_mfma_f32_16x16x32_bf16 v[162:165], v[58:61], v[42:45], v[162:165]
v_add_f32_dpp v0, v157, v156 wave_shr:1 row_mask:0xf bank_mask:0xf
v_add_f32_dpp v1, v5, v155 wave_ror:1 row_mask:0x1 bank_mask:0x1
v_mfma_f32_16x16x32_bf16 v[166:169], v[82:85], v[18:21], v[166:169]
v_add_f32_dpp v8, v6, v150 wave_shr:1 row_mask:0xf bank_mask:0xf
v_add_f32_dpp v1, v0, v155 wave_shr:1 row_mask:0xf bank_mask:0xf
s_setprio 0
v_mfma_f32_16x16x32_bf16 v[170:173], v[82:85], v[20:23], v[170:173]
ds_read_b32 v2, v226 offset:96
v_add_f32_dpp v3, v6, v154 wave_ror:1 row_mask:0x1 bank_mask:0x1
v_add_f32_dpp v3, v1, v154 wave_shr:1 row_mask:0xf bank_mask:0xf
v_mfma_f32_16x16x32_bf16 v[166:169], v[78:81], v[22:25], v[166:169]
v_add_f32_dpp v4, v157, v160 wave_ror:1 row_mask:0x1 bank_mask:0x1
v_add_f32_dpp v7, v0, v159 wave_ror:1 row_mask:0x1 bank_mask:0x1
v_mfma_f32_16x16x32_bf16 v[170:173], v[78:81], v[24:27], v[170:173]
v_add_f32_dpp v4, v161, v160 wave_shr:1 row_mask:0xf bank_mask:0xf
v_add_f32_dpp v86, v1, v158 wave_ror:1 row_mask:0x1 bank_mask:0x1
v_mfma_f32_16x16x32_bf16 v[166:169], v[74:77], v[26:29], v[166:169]
v_add_f32_dpp v5, v161, v164 wave_ror:1 row_mask:0x1 bank_mask:0x1
v_add_f32_dpp v7, v4, v159 wave_shr:1 row_mask:0xf bank_mask:0xf
v_mfma_f32_16x16x32_bf16 v[170:173], v[74:77], v[28:31], v[170:173]
v_add_f32_dpp v5, v165, v164 wave_shr:1 row_mask:0xf bank_mask:0xf
v_add_f32_dpp v6, v4, v163 wave_ror:1 row_mask:0x1 bank_mask:0x1
v_mfma_f32_16x16x32_bf16 v[166:169], v[70:73], v[30:33], v[166:169]
s_waitcnt lgkmcnt(0)
v_cmp_ne_u32 vcc, 1, v2
s_cbranch_vccnz L_f4r
L_f4:
s_setprio 3
ds_read_b64_tr_b16 v[10:11], v224 offset:1024
ds_read_b64_tr_b16 v[12:13], v224 offset:18176
v_mfma_f32_16x16x32_bf16 v[170:173], v[70:73], v[32:35], v[170:173]
s_add_u32 s48, s36, 0x120000
ds_read_b128 v[14:17], v220 offset:3072
ds_read_b64 v[0:1], v221 offset:3072
v_add_f32_dpp v86, v7, v158 wave_shr:1 row_mask:0xf bank_mask:0xf
v_mfma_f32_16x16x32_bf16 v[166:169], v[66:69], v[36:39], v[166:169]
ds_read_b32 v4, v219 offset:2048
v_add_f32_dpp v6, v5, v163 wave_shr:1 row_mask:0xf bank_mask:0xf
v_add_f32_dpp v87, v7, v162 wave_ror:1 row_mask:0x1 bank_mask:0x1
ds_read_b32 v88, v219 offset:2304
v_mfma_f32_16x16x32_bf16 v[170:173], v[66:69], v[38:41], v[170:173]
v_add_f32_dpp v87, v6, v162 wave_shr:1 row_mask:0xf bank_mask:0xf
v_mfma_f32_16x16x32_bf16 v[166:169], v[62:65], v[40:43], v[166:169]
ds_read_b64_tr_b16 v[50:51], v214 offset:2944
v_mfma_f32_16x16x32_bf16 v[170:173], v[62:65], v[42:45], v[170:173]
s_waitcnt lgkmcnt(3)
buffer_store_dwordx4 v[10:13], v222, s[24:27], s48 offen
ds_read_b64_tr_b16 v[52:53], v214 offset:3072
v_mfma_f32_16x16x32_bf16 v[166:169], v[58:61], v[44:47], v[166:169]
v_lshlrev_b32 v2, 16, v0
v_and_b32 v9, 0xffff0000, v0
v_mfma_f32_16x16x32_bf16 v[170:173], v[58:61], v[46:49], v[170:173]
v_lshlrev_b32 v7, 16, v1
v_and_b32 v89, 0xffff0000, v1
ds_read_b32 v90, v219 offset:2560
v_mfma_f32_16x16x32_bf16 v[174:177], v[82:85], v[22:25], v[174:177]
v_mfma_f32_16x16x32_bf16 v[92:95], v[54:57], v[14:17], 0
v_mfma_f32_16x16x32_bf16 v[178:181], v[82:85], v[24:27], v[178:181]
s_waitcnt lgkmcnt(1)
v_lshlrev_b32 v91, 16, v4
v_and_b32 v4, 0xffff0000, v4
v_mfma_f32_16x16x32_bf16 v[174:177], v[78:81], v[26:29], v[174:177]
v_mul_f32 v91, v91, v8
v_mul_f32 v4, v4, v3
v_mfma_f32_16x16x32_bf16 v[178:181], v[78:81], v[28:31], v[178:181]
v_mul_f32 v2, v2, v92
v_mul_f32 v9, v9, v93
v_mfma_f32_16x16x32_bf16 v[174:177], v[74:77], v[30:33], v[174:177]
v_mul_f32 v7, v7, v94
v_mul_f32 v89, v89, v95
v_mfma_f32_16x16x32_bf16 v[178:181], v[74:77], v[32:35], v[178:181]
v_cvt_pk_bf16_f32 v0, v2, v9
s_setprio 2
v_cvt_pk_bf16_f32 v1, v7, v89
ds_write_b64 v221, v[0:1] offset:3072
v_mfma_f32_16x16x32_bf16 v[174:177], v[70:73], v[36:39], v[174:177]
v_cvt_pk_bf16_f32 v3, v91, v4
ds_write_addtid_b32 v3 offset:2048
v_add_f32_dpp v8, v165, v168 wave_ror:1 row_mask:0x1 bank_mask:0x1
v_mfma_f32_16x16x32_bf16 v[178:181], v[70:73], v[38:41], v[178:181]
v_add_f32_dpp v96, v5, v167 wave_ror:1 row_mask:0x1 bank_mask:0x1
v_add_f32_dpp v8, v169, v168 wave_shr:1 row_mask:0xf bank_mask:0xf
v_mfma_f32_16x16x32_bf16 v[174:177], v[66:69], v[40:43], v[174:177]
v_add_f32_dpp v92, v6, v166 wave_ror:1 row_mask:0x1 bank_mask:0x1
v_add_f32_dpp v93, v169, v172 wave_ror:1 row_mask:0x1 bank_mask:0x1
v_mfma_f32_16x16x32_bf16 v[178:181], v[66:69], v[42:45], v[178:181]
v_add_f32_dpp v96, v8, v167 wave_shr:1 row_mask:0xf bank_mask:0xf
v_add_f32_dpp v93, v173, v172 wave_shr:1 row_mask:0xf bank_mask:0xf
s_waitcnt vmcnt(2)
ds_read_b64_tr_b16 v[98:99], v215 offset:40960
ds_read_b64_tr_b16 v[100:101], v215 offset:41216
v_mfma_f32_16x16x32_bf16 v[174:177], v[62:65], v[44:47], v[174:177]
v_add_f32_dpp v89, v8, v171 wave_ror:1 row_mask:0x1 bank_mask:0x1
v_add_f32_dpp v92, v96, v166 wave_shr:1 row_mask:0xf bank_mask:0xf
ds_read_b64_tr_b16 v[0:1], v214 offset:3072
ds_read_b64_tr_b16 v[2:3], v214 offset:3200
v_mfma_f32_16x16x32_bf16 v[178:181], v[62:65], v[46:49], v[178:181]
v_add_f32_dpp v89, v93, v171 wave_shr:1 row_mask:0xf bank_mask:0xf
v_add_f32_dpp v91, v96, v170 wave_ror:1 row_mask:0x1 bank_mask:0x1
ds_read_b64_tr_b16 v[4:5], v214 offset:3328
v_mfma_f32_16x16x32_bf16 v[174:177], v[58:61], v[48:51], v[174:177]
v_add_f32_dpp v91, v89, v170 wave_shr:1 row_mask:0xf bank_mask:0xf
v_lshlrev_b32 v94, 16, v88
v_mfma_f32_16x16x32_bf16 v[178:181], v[58:61], v[50:53], v[178:181]
v_and_b32 v88, 0xffff0000, v88
v_mul_f32 v94, v94, v86
ds_read_b32 v95, v219 offset:2816
v_mfma_f32_16x16x32_bf16 v[182:185], v[82:85], v[26:29], v[182:185]
v_mul_f32 v88, v88, v87
v_cvt_pk_bf16_f32 v97, v94, v88
ds_write_addtid_b32 v97 offset:2304
ds_read_b128 v[102:105], v220 offset:3584
v_mfma_f32_16x16x32_bf16 v[186:189], v[82:85], v[28:31], v[186:189]
v_add_f32_dpp v96, v173, v176 wave_ror:1 row_mask:0x1 bank_mask:0x1
v_add_f32_dpp v106, v93, v175 wave_ror:1 row_mask:0x1 bank_mask:0x1
ds_read_b64 v[108:109], v221 offset:3584
s_waitcnt lgkmcnt(4)
ds_write_b128 v218, v[98:101] offset:3072
v_mfma_f32_16x16x32_bf16 v[182:185], v[78:81], v[30:33], v[182:185]
s_setprio 1
v_add_f32_dpp v96, v177, v176 wave_shr:1 row_mask:0xf bank_mask:0xf
v_add_f32_dpp v86, v89, v174 wave_ror:1 row_mask:0x1 bank_mask:0x1
v_mfma_f32_16x16x32_bf16 v[186:189], v[78:81], v[32:35], v[186:189]
v_add_f32_dpp v87, v177, v180 wave_ror:1 row_mask:0x1 bank_mask:0x1
v_add_f32_dpp v106, v96, v175 wave_shr:1 row_mask:0xf bank_mask:0xf
v_mfma_f32_16x16x32_bf16 v[182:185], v[74:77], v[36:39], v[182:185]
v_add_f32_dpp v87, v181, v180 wave_shr:1 row_mask:0xf bank_mask:0xf
v_add_f32_dpp v88, v96, v179 wave_ror:1 row_mask:0x1 bank_mask:0x1
v_mfma_f32_16x16x32_bf16 v[186:189], v[74:77], v[38:41], v[186:189]
v_add_f32_dpp v86, v106, v174 wave_shr:1 row_mask:0xf bank_mask:0xf
v_add_f32_dpp v88, v87, v179 wave_shr:1 row_mask:0xf bank_mask:0xf
v_mfma_f32_16x16x32_bf16 v[182:185], v[70:73], v[40:43], v[182:185]
v_add_f32_dpp v93, v106, v178 wave_ror:1 row_mask:0x1 bank_mask:0x1
v_add_f32_dpp v93, v88, v178 wave_shr:1 row_mask:0xf bank_mask:0xf
v_mfma_f32_16x16x32_bf16 v[186:189], v[70:73], v[42:45], v[186:189]
s_waitcnt lgkmcnt(0)
v_lshlrev_b32 v89, 16, v108
v_and_b32 v94, 0xffff0000, v108
v_mfma_f32_16x16x32_bf16 v[182:185], v[66:69], v[44:47], v[182:185]
v_lshlrev_b32 v97, 16, v109
v_and_b32 v98, 0xffff0000, v109
v_mfma_f32_16x16x32_bf16 v[186:189], v[66:69], v[46:49], v[186:189]
v_mfma_f32_16x16x32_bf16 v[110:113], v[54:57], v[102:105], 0
v_mfma_f32_16x16x32_bf16 v[182:185], v[62:65], v[48:51], v[182:185]
ds_read_b64_tr_b16 v[6:7], v214 offset:3456
v_lshlrev_b32 v96, 16, v90
v_and_b32 v90, 0xffff0000, v90
v_mfma_f32_16x16x32_bf16 v[186:189], v[62:65], v[50:53], v[186:189]
ds_read_b64_tr_b16 v[8:9], v214 offset:3584
v_mul_f32 v96, v96, v92
v_mul_f32 v90, v90, v91
v_mfma_f32_16x16x32_bf16 v[182:185], v[58:61], v[0:3], v[182:185]
v_mul_f32 v89, v89, v110
v_mul_f32 v94, v94, v111
v_mfma_f32_16x16x32_bf16 v[186:189], v[58:61], v[2:5], v[186:189]
v_mul_f32 v97, v97, v112
v_mul_f32 v98, v98, v113
v_mfma_f32_16x16x32_bf16 v[190:193], v[82:85], v[30:33], v[190:193]
v_cvt_pk_bf16_f32 v54, v89, v94
s_setprio 0
v_cvt_pk_bf16_f32 v55, v97, v98
ds_write_b64 v221, v[54:55] offset:3584
v_mfma_f32_16x16x32_bf16 v[194:197], v[82:85], v[32:35], v[194:197]
v_cvt_pk_bf16_f32 v56, v96, v90
ds_write_addtid_b32 v56 offset:2560
v_lshlrev_b32 v57, 16, v95
v_mfma_f32_16x16x32_bf16 v[190:193], v[78:81], v[36:39], v[190:193]
v_and_b32 v95, 0xffff0000, v95
v_mul_f32 v57, v57, v86
v_mfma_f32_16x16x32_bf16 v[194:197], v[78:81], v[38:41], v[194:197]
v_mul_f32 v95, v95, v93
v_cvt_pk_bf16_f32 v89, v57, v95
ds_write_addtid_b32 v89 offset:2816
ds_write_b32 v227, v228 offset:128
v_mfma_f32_16x16x32_bf16 v[190:193], v[74:77], v[40:43], v[190:193]
v_add_f32_dpp v18, v181, v184 wave_ror:1 row_mask:0x1 bank_mask:0x1
v_add_f32_dpp v19, v87, v183 wave_ror:1 row_mask:0x1 bank_mask:0x1
v_mfma_f32_16x16x32_bf16 v[194:197], v[74:77], v[42:45], v[194:197]
v_add_f32_dpp v18, v185, v184 wave_shr:1 row_mask:0xf bank_mask:0xf
v_add_f32_dpp v20, v88, v182 wave_ror:1 row_mask:0x1 bank_mask:0x1
v_mfma_f32_16x16x32_bf16 v[190:193], v[70:73], v[44:47], v[190:193]
v_add_f32_dpp v21, v185, v188 wave_ror:1 row_mask:0x1 bank_mask:0x1
v_add_f32_dpp v19, v18, v183 wave_shr:1 row_mask:0xf bank_mask:0xf
v_mfma_f32_16x16x32_bf16 v[194:197], v[70:73], v[46:49], v[194:197]
v_add_f32_dpp v21, v189, v188 wave_shr:1 row_mask:0xf bank_mask:0xf
v_add_f32_dpp v22, v18, v187 wave_ror:1 row_mask:0x1 bank_mask:0x1
v_mfma_f32_16x16x32_bf16 v[190:193], v[66:69], v[48:51], v[190:193]
v_add_f32_dpp v20, v19, v182 wave_shr:1 row_mask:0xf bank_mask:0xf
v_add_f32_dpp v22, v21, v187 wave_shr:1 row_mask:0xf bank_mask:0xf
ds_read_b32 v23, v226 offset:128
v_mfma_f32_16x16x32_bf16 v[194:197], v[66:69], v[50:53], v[194:197]
v_add_f32_dpp v24, v19, v186 wave_ror:1 row_mask:0x1 bank_mask:0x1
v_add_f32_dpp v24, v22, v186 wave_shr:1 row_mask:0xf bank_mask:0xf
v_mfma_f32_16x16x32_bf16 v[190:193], v[62:65], v[0:3], v[190:193]
ds_read_b64_tr_b16 v[10:11], v214 offset:3712
v_mfma_f32_16x16x32_bf16 v[194:197], v[62:65], v[2:5], v[194:197]
ds_read_b64_tr_b16 v[12:13], v214 offset:3840
s_waitcnt lgkmcnt(3)
v_mfma_f32_16x16x32_bf16 v[190:193], v[58:61], v[4:7], v[190:193]
v_mfma_f32_16x16x32_bf16 v[194:197], v[58:61], v[6:9], v[194:197]
s_waitcnt lgkmcnt(2)
v_cmp_ne_u32 vcc, 1, v23
s_cbranch_vccnz L_f5r
L_f5:
s_setprio 3
ds_read_b64_tr_b16 v[26:27], v224 offset:2048
ds_read_b64_tr_b16 v[28:29], v224 offset:19200
v_mfma_f32_16x16x32_bf16 v[198:201], v[82:85], v[36:39], v[198:201]
s_add_u32 s48, s36, 0x240000
ds_read_b32 v18, v219 offset:3072
ds_read_b32 v19, v219 offset:3328
v_mfma_f32_16x16x32_bf16 v[202:205], v[82:85], v[38:41], v[202:205]
v_add_f32_dpp v25, v189, v192 wave_ror:1 row_mask:0x1 bank_mask:0x1
v_add_f32_dpp v30, v21, v191 wave_ror:1 row_mask:0x1 bank_mask:0x1
v_mfma_f32_16x16x32_bf16 v[198:201], v[78:81], v[40:43], v[198:201]
v_add_f32_dpp v25, v193, v192 wave_shr:1 row_mask:0xf bank_mask:0xf
v_add_f32_dpp v23, v22, v190 wave_ror:1 row_mask:0x1 bank_mask:0x1
v_mfma_f32_16x16x32_bf16 v[202:205], v[78:81], v[42:45], v[202:205]
v_add_f32_dpp v31, v193, v196 wave_ror:1 row_mask:0x1 bank_mask:0x1
v_add_f32_dpp v30, v25, v191 wave_shr:1 row_mask:0xf bank_mask:0xf
v_mfma_f32_16x16x32_bf16 v[198:201], v[74:77], v[44:47], v[198:201]
v_add_f32_dpp v31, v197, v196 wave_shr:1 row_mask:0xf bank_mask:0xf
v_add_f32_dpp v32, v25, v195 wave_ror:1 row_mask:0x1 bank_mask:0x1
s_waitcnt lgkmcnt(0)
buffer_store_dwordx4 v[26:29], v222, s[24:27], s48 offen
ds_read_b64_tr_b16 v[14:15], v214 offset:3968
v_mfma_f32_16x16x32_bf16 v[202:205], v[74:77], v[46:49], v[202:205]
s_setprio 2
v_add_f32_dpp v23, v30, v190 wave_shr:1 row_mask:0xf bank_mask:0xf
v_add_f32_dpp v32, v31, v195 wave_shr:1 row_mask:0xf bank_mask:0xf
v_mfma_f32_16x16x32_bf16 v[198:201], v[70:73], v[48:51], v[198:201]
v_add_f32_dpp v21, v30, v194 wave_ror:1 row_mask:0x1 bank_mask:0x1
v_add_f32_dpp v21, v32, v194 wave_shr:1 row_mask:0xf bank_mask:0xf
v_mfma_f32_16x16x32_bf16 v[202:205], v[70:73], v[50:53], v[202:205]
v_lshlrev_b32 v22, 16, v18
v_and_b32 v18, 0xffff0000, v18
v_mfma_f32_16x16x32_bf16 v[198:201], v[66:69], v[0:3], v[198:201]
v_mul_f32 v22, v22, v20
v_mul_f32 v18, v18, v24
v_mfma_f32_16x16x32_bf16 v[202:205], v[66:69], v[2:5], v[202:205]
v_cvt_pk_bf16_f32 v25, v22, v18
ds_write_addtid_b32 v25 offset:3072
v_lshlrev_b32 v26, 16, v19
v_mfma_f32_16x16x32_bf16 v[198:201], v[62:65], v[4:7], v[198:201]
v_and_b32 v19, 0xffff0000, v19
s_setprio 1
v_mul_f32 v26, v26, v23
v_mfma_f32_16x16x32_bf16 v[202:205], v[62:65], v[6:9], v[202:205]
v_mul_f32 v19, v19, v21
v_cvt_pk_bf16_f32 v27, v26, v19
ds_write_addtid_b32 v27 offset:3328
ds_read_b64_tr_b16 v[16:17], v214 offset:4096
v_mfma_f32_16x16x32_bf16 v[198:201], v[58:61], v[8:11], v[198:201]
ds_write_b32 v227, v228 offset:160
v_mfma_f32_16x16x32_bf16 v[202:205], v[58:61], v[10:13], v[202:205]
ds_read_b32 v18, v219 offset:3584
v_mfma_f32_16x16x32_bf16 v[206:209], v[82:85], v[40:43], v[206:209]
v_mfma_f32_16x16x32_bf16 v[206:209], v[78:81], v[44:47], v[206:209]
s_nop 2
v_add_f32_dpp v20, v197, v200 wave_ror:1 row_mask:0x1 bank_mask:0x1
v_add_f32_dpp v22, v31, v199 wave_ror:1 row_mask:0x1 bank_mask:0x1
v_mfma_f32_16x16x32_bf16 v[206:209], v[74:77], v[48:51], v[206:209]
v_add_f32_dpp v20, v201, v200 wave_shr:1 row_mask:0xf bank_mask:0xf
v_add_f32_dpp v19, v32, v198 wave_ror:1 row_mask:0x1 bank_mask:0x1
v_mfma_f32_16x16x32_bf16 v[206:209], v[70:73], v[0:3], v[206:209]
s_setprio 0
v_add_f32_dpp v21, v201, v204 wave_ror:1 row_mask:0x1 bank_mask:0x1
v_add_f32_dpp v22, v20, v199 wave_shr:1 row_mask:0xf bank_mask:0xf
ds_read_b32 v23, v226 offset:160
v_mfma_f32_16x16x32_bf16 v[206:209], v[66:69], v[4:7], v[206:209]
v_add_f32_dpp v21, v205, v204 wave_shr:1 row_mask:0xf bank_mask:0xf
v_add_f32_dpp v24, v20, v203 wave_ror:1 row_mask:0x1 bank_mask:0x1
v_mfma_f32_16x16x32_bf16 v[206:209], v[62:65], v[8:11], v[206:209]
v_add_f32_dpp v19, v22, v198 wave_shr:1 row_mask:0xf bank_mask:0xf
v_add_f32_dpp v24, v21, v203 wave_shr:1 row_mask:0xf bank_mask:0xf
s_waitcnt lgkmcnt(1)
v_mfma_f32_16x16x32_bf16 v[206:209], v[58:61], v[12:15], v[206:209]
v_add_f32_dpp v25, v22, v202 wave_ror:1 row_mask:0x1 bank_mask:0x1
v_add_f32_dpp v25, v24, v202 wave_shr:1 row_mask:0xf bank_mask:0xf
v_mfma_f32_16x16x32_bf16 v[210:213], v[82:85], v[42:45], v[210:213]
v_lshlrev_b32 v26, 16, v18
v_and_b32 v18, 0xffff0000, v18
v_mfma_f32_16x16x32_bf16 v[210:213], v[78:81], v[46:49], v[210:213]
s_waitcnt lgkmcnt(0)
v_cmp_ne_u32 vcc, 1, v23
s_cbranch_vccnz L_f6r
L_f6:
ds_read_b64_tr_b16 v[28:29], v225 offset:3072
ds_read_b64_tr_b16 v[30:31], v225 offset:20224
v_mfma_f32_16x16x32_bf16 v[210:213], v[74:77], v[50:53], v[210:213]
v_add_f32_dpp v20, v205, v208 wave_ror:1 row_mask:0x1 bank_mask:0x1
v_add_f32_dpp v27, v21, v207 wave_ror:1 row_mask:0x1 bank_mask:0x1
s_add_u32 s48, s35, 0x360000
v_mfma_f32_16x16x32_bf16 v[210:213], v[70:73], v[2:5], v[210:213]
v_add_f32_dpp v20, v209, v208 wave_shr:1 row_mask:0xf bank_mask:0xf
v_add_f32_dpp v22, v24, v206 wave_ror:1 row_mask:0x1 bank_mask:0x1
v_mfma_f32_16x16x32_bf16 v[210:213], v[66:69], v[6:9], v[210:213]
v_add_f32_dpp v27, v20, v207 wave_shr:1 row_mask:0xf bank_mask:0xf
v_mul_f32 v26, v26, v19
v_mfma_f32_16x16x32_bf16 v[210:213], v[62:65], v[10:13], v[210:213]
v_add_f32_dpp v22, v27, v206 wave_shr:1 row_mask:0xf bank_mask:0xf
v_mul_f32 v18, v18, v25
v_mfma_f32_16x16x32_bf16 v[210:213], v[58:61], v[14:17], v[210:213]
ds_read_b32 v23, v219 offset:3840
s_mov_b32 exec_hi, 0
s_waitcnt lgkmcnt(1)
buffer_store_dwordx4 v[28:31], v222, s[24:27], s48 offen
s_mov_b64 exec, -1
v_cvt_pk_bf16_f32 v21, v26, v18
ds_write_addtid_b32 v21 offset:3584
s_nop 0
v_add_f32_dpp v24, v209, v212 wave_ror:1 row_mask:0x1 bank_mask:0x1
v_add_f32_dpp v32, v20, v211 wave_ror:1 row_mask:0x1 bank_mask:0x1
v_add_f32_dpp v24, v213, v212 wave_shr:1 row_mask:0xf bank_mask:0xf
v_add_f32_dpp v19, v27, v210 wave_ror:1 row_mask:0x1 bank_mask:0x1
s_nop 0
v_add_f32_dpp v32, v24, v211 wave_shr:1 row_mask:0xf bank_mask:0xf
s_nop 1
v_add_f32_dpp v19, v32, v210 wave_shr:1 row_mask:0xf bank_mask:0xf
s_waitcnt lgkmcnt(1)
v_lshlrev_b32 v0, 16, v23
v_and_b32 v23, 0xffff0000, v23
v_mul_f32 v0, v0, v22
v_mul_f32 v23, v23, v19
v_cvt_pk_bf16_f32 v1, v0, v23
ds_write_addtid_b32 v1 offset:3840
s_add_u32 s48, s35, 0x3f0000
s_waitcnt lgkmcnt(0)
s_barrier
ds_read_b64_tr_b16 v[2:3], v225 offset:3584
ds_read_b64_tr_b16 v[4:5], v225 offset:20736
s_mov_b32 exec_hi, 0
s_waitcnt lgkmcnt(0)
buffer_store_dwordx4 v[2:5], v222, s[24:27], s48 offen
s_mov_b64 exec, -1
s_endpgm
.p2align 6
L_A2:
s_lshl_b32 s50, s36, 1
s_and_b32 s44, s50, -4
s_load_dword s45, s[22:23], s44
s_load_dword s46, s[28:29], s44
s_mov_b32 s26, 0x480000
s_mov_b32 s27, 0x20000
s_mov_b32 s43, 0x20000
s_lshr_b32 s31, s30, 3
s_bfe_u32 s48, s30, 0x10001
s_cmp_lt_u32 s30, 16
s_cselect_b32 s31, s31, s48
s_mov_b32 s42, 0x1b0000
s_cmp_eq_u32 s31, 1
s_cselect_b32 s42, 0x240000, s42
s_lshl_b32 s35, s34, 4
s_mul_i32 s38, s3, 0x2240
s_mul_i32 s39, s3, 0x10a0
s_add_u32 s39, s39, 0x1dbb0
s_mul_i32 s32, s3, 0x48000
v_bfe_u32 v2, v0, 4, 2
s_setprio 2
v_bfe_u32 v3, v0, 2, 2
v_and_b32 v10, 3, v0
v_mul_u32_u24 v96, 0x1200, v1
v_add_u32 v96, s35, v96
s_lshl_b32 s47, s33, 7
s_sub_u32 s49, 0x400, s47
v_bfe_u32 v11, v1, 1, 3
v_mul_u32_u24 v11, 0x480, v11
v_and_b32 v12, 1, v1
v_mul_u32_u24 v12, s49, v12
v_add3_u32 v11, v11, v12, s52
s_add_u32 s48, s4, 0x90000
s_addc_u32 s49, s5, 0
v_mov_b32 v14, s48
v_mov_b32 v15, s49
s_add_u32 s48, s6, 0x90000
s_addc_u32 s49, s7, 0
s_mov_b32 exec_lo, 0xffff0000
v_mov_b32 v14, s48
v_mov_b32 v15, s49
s_add_u32 s48, s8, 0
s_addc_u32 s49, s9, 0
s_mov_b32 exec_lo, 0
v_mov_b32 v14, s48
v_mov_b32 v15, s49
s_add_u32 s48, s8, 0x90000
s_addc_u32 s49, s9, 0
s_mov_b32 exec_hi, 0xffff0000
v_mov_b32 v14, s48
v_mov_b32 v15, s49
s_mov_b64 exec, -1
v_add_co_u32 v14, vcc, v14, v11
s_nop 1
v_addc_co_u32 v15, vcc, 0, v15, vcc
s_add_u32 s48, s4, 0x120000
s_addc_u32 s49, s5, 0
v_mov_b32 v16, s48
v_mov_b32 v17, s49
s_add_u32 s48, s6, 0x120000
s_addc_u32 s49, s7, 0
s_mov_b32 exec_lo, 0xffff0000
v_mov_b32 v16, s48
v_mov_b32 v17, s49
s_setprio 1
s_mov_b64 exec, -1
v_add_co_u32 v16, vcc, v16, v11
s_nop 1
v_addc_co_u32 v17, vcc, 0, v17, vcc
s_add_u32 s48, s8, 0x120000
s_addc_u32 s49, s9, 0
v_mov_b32 v48, s48
v_mov_b32 v49, s49
s_add_u32 s48, s8, 0x1b0000
s_addc_u32 s49, s9, 0
s_mov_b32 exec_lo, 0xffff0000
v_mov_b32 v48, s48
v_mov_b32 v49, s49
s_mov_b64 exec, -1
v_add_co_u32 v48, vcc, v48, v11
s_nop 1
v_addc_co_u32 v49, vcc, 0, v49, vcc
v_lshlrev_b32 v0, 2, v2
v_add_u32 v0, v0, v3
v_lshlrev_b32 v105, 2, v10
v_sub_u32 v105, v105, v0
v_lshlrev_b32 v105, 3, v105
v_add_u32 v105, 0x78, v105
v_add_u32 v105, s38, v105
v_add_u32 v106, v0, v10
v_lshlrev_b32 v106, 3, v106
v_add_u32 v106, 8, v106
v_add_u32 v106, s39, v106
v_lshl_add_u32 v97, v1, 2, s38
s_lshl_b32 s52, s3, 8
s_add_u32 s53, s52, 0xf1e0
s_lshl_b32 s47, s3, 9
s_add_u32 s47, s47, 0x1dc50
v_lshl_add_u32 v107, v1, 3, s47
v_mul_u32_u24 v11, 0x2240, v3
v_lshl_add_u32 v11, v2, 5, v11
v_lshl_add_u32 v11, v10, 3, v11
v_add_u32 v11, 0x1100, v11
v_and_b32 v0, 31, v1
v_lshrrev_b32 v13, 5, v1
s_setprio 0
v_lshlrev_b32 v18, 4, v13
v_add_u32 v18, s52, v18
v_mov_b32 v19, 0x810
v_add_u32 v12, 31, v0
v_and_b32 v12, 31, v12
v_mad_u32_u24 v98, v12, v19, v18
v_lshlrev_b32 v12, 2, v0
v_lshlrev_b32 v108, 3, v2
v_lshl_add_u32 v108, v3, 1, v108
v_lshrrev_b32 v20, 1, v10
v_add_u32 v108, v108, v20
v_and_b32 v20, 1, v10
v_lshl_add_u32 v108, v20, 6, v108
v_mul_u32_u24 v108, 0x900, v108
v_add_u32 v108, s35, v108
s_mul_i32 s49, s3, 0x80
v_add_u32 v109, s49, v11
s_and_b32 s48, s49, 0xff
s_lshr_b32 s48, s48, 2
s_lshr_b32 s47, s49, 8
s_lshl_b32 s47, s47, 7
s_add_u32 s48, s48, s47
s_mul_i32 s54, s48, 0x900
s_mul_i32 s49, s3, 64
v_add_u32 v110, s49, v11
s_and_b32 s48, s49, 0xff
s_lshr_b32 s48, s48, 2
s_lshr_b32 s47, s49, 8
s_lshl_b32 s47, s47, 7
s_add_u32 s48, s48, s47
s_mul_i32 s55, s48, 0x900
s_mul_i32 s49, s3, 32
v_add_u32 v99, s49, v11
s_and_b32 s48, s49, 0xff
s_lshr_b32 s48, s48, 2
s_lshr_b32 s47, s49, 8
s_lshl_b32 s47, s47, 7
s_add_u32 s48, s48, s47
s_mul_i32 s36, s48, 0x900
s_mov_b32 s48, 0x76543210
s_mov_b32 s49, 0xcbaaa988
v_lshrrev_b64 v[2:3], v12, s[48:49]
v_and_b32 v100, 15, v2
v_mad_u32_u24 v100, v100, v19, v18
s_setprio 3
v_add_u32 v100, 0x10200, v100
s_mov_b32 s48, 0x55432210
s_mov_b32 s49, 0xdcba9876
s_mov_b32 exec_lo, 0xffff0000
s_mov_b32 exec_hi, 0xffff0000
v_lshrrev_b64 v[2:3], v12, s[48:49]
v_and_b32 v100, 15, v2
v_mad_u32_u24 v100, v100, v19, v18
v_add_u32 v100, 0x16ad0, v100
s_mov_b64 exec, -1
s_add_u32 s47, s38, 0x60
v_lshl_add_u32 v12, v0, 4, s47
v_lshl_add_u32 v101, v13, 3, v12
v_lshl_add_u32 v102, v13, 9, v12
v_lshl_add_u32 v103, v13, 10, v12
v_and_b32 v12, 1, v1
v_mul_u32_u24 v12, 0x404, v12
v_add_u32 v111, 0x7060100, v12
v_mov_b32 v10, 0
v_lshlrev_b32 v2, 2, v1
v_and_b32 v112, 28, v2
v_add_u32 v112, 0x260b0, v112
v_add_u32 v2, 0x260b0, v2
ds_write_b32 v2, v10
s_lshl_b32 s47, s3, 2
s_add_u32 s47, s47, 0x260b0
v_mov_b32 v113, s47
v_mov_b32 v114, 1
v_mov_b32 v115, 0
v_lshl_add_u32 v0, v1, 2, s39
s_mov_b32 exec_hi, 0xff
ds_write_b32 v0, v115
s_mov_b64 exec, -1
s_and_b32 s50, s50, 2
s_lshl_b32 s50, s50, 3
s_waitcnt lgkmcnt(0)
s_lshr_b32 s45, s45, s50
s_lshl_b32 s45, s45, 16
s_lshr_b32 s46, s46, s50
s_lshl_b32 s46, s46, 16
v_mov_b32 v2, 0x3fb8aa3b
v_mul_f32 v2, s45, v2
s_setprio 2
v_exp_f32 v2, v2
v_mov_b32 v116, 0
v_mov_b32 v0, 0x3f80
v_cvt_pk_bf16_f32 v2, v2, v2
v_and_b32 v2, 0xffff0000, v2
v_writelane_b32 v116, s46, 0
s_mov_b32 m0, s53
s_nop 0
ds_write_addtid_b32 v0 offset:2064
s_mov_b32 s50, 0x5040100
s_mov_b32 s51, 0x7060302
s_waitcnt vmcnt(0)
s_cmp_ge_u32 s3, 4
s_cbranch_scc1 L_pf1
s_cmp_lt_u32 s33, 4
s_mov_b32 exec_lo, 0x55555555
s_cselect_b32 exec_lo, 0xffffffff, exec_lo
s_mov_b32 exec_hi, 0xffffffff
s_cselect_b32 exec_hi, 0x55555555, exec_hi
global_load_dword v104, v[14:15], off
s_mov_b64 exec, -1
L_pf1:
v_lshlrev_b32 v0, 16, v4
v_lshlrev_b32 v1, 16, v5
v_lshlrev_b32 v10, 16, v6
v_lshlrev_b32 v11, 16, v7
v_lshlrev_b32 v12, 16, v8
v_lshlrev_b32 v13, 16, v9
v_mul_f32 v0, v2, v0
v_mul_f32 v1, v2, v1
v_mul_f32 v0, 0x3fb8aa3b, v0
v_mul_f32 v1, 0x3e22f983, v1
v_mul_f32 v3, 0x41000000, v0
v_mul_f32 v14, 0x41000000, v1
v_exp_f32 v3, v3
v_fract_f32 v14, v14
v_cos_f32 v18, v14
v_sin_f32 v19, v14
v_mul_f32 v10, v2, v10
s_setprio 1
v_mul_f32 v11, v2, v11
v_exp_f32 v15, v0
v_fract_f32 v20, v1
v_cos_f32 v32, v20
v_sin_f32 v33, v20
v_mul_f32 v18, v3, v18
v_mul_f32 v19, v3, v19
v_mul_f32 v32, v15, v32
v_mul_f32 v33, v15, v33
v_pk_mul_f32 v[22:23], v[12:13], v[10:11] op_sel:[0,0] op_sel_hi:[1,0]
v_pk_fma_f32 v[22:23], v[12:13], v[10:11], v[22:23] op_sel:[1,1,0] op_sel_hi:[0,1,1] neg_lo:[1,0,0]
s_mov_b32 m0, s52
v_pk_mul_f32 v[24:25], v[18:19], v[18:19] op_sel:[0,0] op_sel_hi:[1,0]
v_cvt_pk_bf16_f32 v14, v18, v19
v_pk_fma_f32 v[24:25], v[18:19], v[18:19], v[24:25] op_sel:[1,1,0] op_sel_hi:[0,1,1] neg_lo:[1,0,0]
v_cvt_pk_bf16_f32 v0, v24, v25
v_pk_mul_f32 v[26:27], v[24:25], v[24:25] op_sel:[0,0] op_sel_hi:[1,0]
ds_write_addtid_b32 v14
v_pk_mul_f32 v[20:21], v[18:19], v[24:25] op_sel:[0,0] op_sel_hi:[1,0]
ds_write_addtid_b32 v0 offset:2064
v_pk_fma_f32 v[26:27], v[24:25], v[24:25], v[26:27] op_sel:[1,1,0] op_sel_hi:[0,1,1] neg_lo:[1,0,0]
v_pk_fma_f32 v[20:21], v[18:19], v[24:25], v[20:21] op_sel:[1,1,0] op_sel_hi:[0,1,1] neg_lo:[1,0,0]
v_cvt_pk_bf16_f32 v1, v26, v27
v_cvt_pk_bf16_f32 v3, v20, v21
v_pk_mul_f32 v[10:11], v[26:27], v[24:25] op_sel:[0,0] op_sel_hi:[1,0]
v_pk_mul_f32 v[12:13], v[20:21], v[24:25] op_sel:[0,0] op_sel_hi:[1,0]
ds_write_addtid_b32 v1 offset:6192
ds_write_addtid_b32 v3 offset:4128
v_pk_fma_f32 v[10:11], v[26:27], v[24:25], v[10:11] op_sel:[1,1,0] op_sel_hi:[0,1,1] neg_lo:[1,0,0]
v_pk_fma_f32 v[12:13], v[20:21], v[24:25], v[12:13] op_sel:[1,1,0] op_sel_hi:[0,1,1] neg_lo:[1,0,0]
v_cvt_pk_bf16_f32 v14, v10, v11
v_cvt_pk_bf16_f32 v15, v12, v13
s_setprio 0
v_pk_mul_f32 v[28:29], v[10:11], v[24:25] op_sel:[0,0] op_sel_hi:[1,0]
v_pk_mul_f32 v[30:31], v[12:13], v[24:25] op_sel:[0,0] op_sel_hi:[1,0]
ds_write_addtid_b32 v14 offset:10320
ds_write_addtid_b32 v15 offset:8256
v_pk_fma_f32 v[28:29], v[10:11], v[24:25], v[28:29] op_sel:[1,1,0] op_sel_hi:[0,1,1] neg_lo:[1,0,0]
v_pk_fma_f32 v[30:31], v[12:13], v[24:25], v[30:31] op_sel:[1,1,0] op_sel_hi:[0,1,1] neg_lo:[1,0,0]
v_cvt_pk_bf16_f32 v0, v28, v29
v_cvt_pk_bf16_f32 v1, v30, v31
v_pk_mul_f32 v[26:27], v[28:29], v[24:25] op_sel:[0,0] op_sel_hi:[1,0]
v_pk_mul_f32 v[20:21], v[30:31], v[24:25] op_sel:[0,0] op_sel_hi:[1,0]
ds_write_addtid_b32 v0 offset:14448
ds_write_addtid_b32 v1 offset:12384
v_pk_fma_f32 v[26:27], v[28:29], v[24:25], v[26:27] op_sel:[1,1,0] op_sel_hi:[0,1,1] neg_lo:[1,0,0]
v_pk_fma_f32 v[20:21], v[30:31], v[24:25], v[20:21] op_sel:[1,1,0] op_sel_hi:[0,1,1] neg_lo:[1,0,0]
v_cvt_pk_bf16_f32 v3, v26, v27
v_cvt_pk_bf16_f32 v14, v20, v21
v_pk_mul_f32 v[34:35], v[26:27], v[24:25] op_sel:[0,0] op_sel_hi:[1,0]
v_pk_mul_f32 v[10:11], v[20:21], v[24:25] op_sel:[0,0] op_sel_hi:[1,0]
ds_write_addtid_b32 v3 offset:18576
ds_write_addtid_b32 v14 offset:16512
v_pk_fma_f32 v[34:35], v[26:27], v[24:25], v[34:35] op_sel:[1,1,0] op_sel_hi:[0,1,1] neg_lo:[1,0,0]
v_pk_fma_f32 v[10:11], v[20:21], v[24:25], v[10:11] op_sel:[1,1,0] op_sel_hi:[0,1,1] neg_lo:[1,0,0]
v_cvt_pk_bf16_f32 v12, v34, v35
v_cvt_pk_bf16_f32 v0, v10, v11
v_pk_mul_f32 v[36:37], v[34:35], v[24:25] op_sel:[0,0] op_sel_hi:[1,0]
v_pk_mul_f32 v[28:29], v[10:11], v[24:25] op_sel:[0,0] op_sel_hi:[1,0]
ds_write_addtid_b32 v12 offset:22704
ds_write_addtid_b32 v0 offset:20640
v_pk_fma_f32 v[36:37], v[34:35], v[24:25], v[36:37] op_sel:[1,1,0] op_sel_hi:[0,1,1] neg_lo:[1,0,0]
v_pk_fma_f32 v[28:29], v[10:11], v[24:25], v[28:29] op_sel:[1,1,0] op_sel_hi:[0,1,1] neg_lo:[1,0,0]
v_cvt_pk_bf16_f32 v1, v36, v37
v_cvt_pk_bf16_f32 v3, v28, v29
v_pk_mul_f32 v[14:15], v[36:37], v[24:25] op_sel:[0,0] op_sel_hi:[1,0]
v_pk_mul_f32 v[26:27], v[28:29], v[24:25] op_sel:[0,0] op_sel_hi:[1,0]
ds_write_addtid_b32 v1 offset:26832
ds_write_addtid_b32 v3 offset:24768
v_pk_fma_f32 v[14:15], v[36:37], v[24:25], v[14:15] op_sel:[1,1,0] op_sel_hi:[0,1,1] neg_lo:[1,0,0]
s_setprio 3
v_pk_fma_f32 v[26:27], v[28:29], v[24:25], v[26:27] op_sel:[1,1,0] op_sel_hi:[0,1,1] neg_lo:[1,0,0]
v_cvt_pk_bf16_f32 v12, v14, v15
s_cmp_ge_u32 s3, 4
s_cbranch_scc1 L_pf2
s_cmp_lt_u32 s33, 4
s_mov_b32 exec_lo, 0x55555555
s_cselect_b32 exec_lo, 0xffffffff, exec_lo
s_mov_b32 exec_hi, 0
s_cselect_b32 exec_hi, 0, exec_hi
global_load_dword v104, v[16:17], off
s_mov_b64 exec, -1
L_pf2:
v_cvt_pk_bf16_f32 v0, v26, v27
v_pk_mul_f32 v[10:11], v[14:15], v[24:25] op_sel:[0,0] op_sel_hi:[1,0]
v_pk_mul_f32 v[20:21], v[26:27], v[24:25] op_sel:[0,0] op_sel_hi:[1,0]
ds_write_addtid_b32 v12 offset:30960
ds_write_addtid_b32 v0 offset:28896
v_pk_fma_f32 v[10:11], v[14:15], v[24:25], v[10:11] op_sel:[1,1,0] op_sel_hi:[0,1,1] neg_lo:[1,0,0]
v_pk_fma_f32 v[20:21], v[26:27], v[24:25], v[20:21] op_sel:[1,1,0] op_sel_hi:[0,1,1] neg_lo:[1,0,0]
v_cvt_pk_bf16_f32 v1, v10, v11
v_cvt_pk_bf16_f32 v3, v20, v21
v_pk_mul_f32 v[28:29], v[10:11], v[24:25] op_sel:[0,0] op_sel_hi:[1,0]
v_pk_mul_f32 v[16:17], v[20:21], v[24:25] op_sel:[0,0] op_sel_hi:[1,0]
ds_write_addtid_b32 v1 offset:35088
ds_write_addtid_b32 v3 offset:33024
v_pk_fma_f32 v[28:29], v[10:11], v[24:25], v[28:29] op_sel:[1,1,0] op_sel_hi:[0,1,1] neg_lo:[1,0,0]
v_pk_fma_f32 v[16:17], v[20:21], v[24:25], v[16:17] op_sel:[1,1,0] op_sel_hi:[0,1,1] neg_lo:[1,0,0]
v_cvt_pk_bf16_f32 v13, v28, v29
v_cvt_pk_bf16_f32 v12, v16, v17
v_pk_mul_f32 v[30:31], v[28:29], v[24:25] op_sel:[0,0] op_sel_hi:[1,0]
v_pk_mul_f32 v[14:15], v[16:17], v[24:25] op_sel:[0,0] op_sel_hi:[1,0]
ds_write_addtid_b32 v13 offset:39216
ds_write_addtid_b32 v12 offset:37152
v_pk_fma_f32 v[30:31], v[28:29], v[24:25], v[30:31] op_sel:[1,1,0] op_sel_hi:[0,1,1] neg_lo:[1,0,0]
v_pk_fma_f32 v[14:15], v[16:17], v[24:25], v[14:15] op_sel:[1,1,0] op_sel_hi:[0,1,1] neg_lo:[1,0,0]
v_cvt_pk_bf16_f32 v0, v30, v31
v_cvt_pk_bf16_f32 v1, v14, v15
v_pk_mul_f32 v[26:27], v[30:31], v[24:25] op_sel:[0,0] op_sel_hi:[1,0]
v_pk_mul_f32 v[10:11], v[14:15], v[24:25] op_sel:[0,0] op_sel_hi:[1,0]
ds_write_addtid_b32 v0 offset:43344
ds_write_addtid_b32 v1 offset:41280
v_pk_fma_f32 v[26:27], v[30:31], v[24:25], v[26:27] op_sel:[1,1,0] op_sel_hi:[0,1,1] neg_lo:[1,0,0]
s_setprio 2
v_pk_fma_f32 v[10:11], v[14:15], v[24:25], v[10:11] op_sel:[1,1,0] op_sel_hi:[0,1,1] neg_lo:[1,0,0]
v_cvt_pk_bf16_f32 v3, v26, v27
v_cvt_pk_bf16_f32 v12, v10, v11
v_pk_mul_f32 v[20:21], v[26:27], v[24:25] op_sel:[0,0] op_sel_hi:[1,0]
v_pk_mul_f32 v[16:17], v[10:11], v[24:25] op_sel:[0,0] op_sel_hi:[1,0]
ds_write_addtid_b32 v3 offset:47472
ds_write_addtid_b32 v12 offset:45408
v_pk_fma_f32 v[20:21], v[26:27], v[24:25], v[20:21] op_sel:[1,1,0] op_sel_hi:[0,1,1] neg_lo:[1,0,0]
v_pk_fma_f32 v[16:17], v[10:11], v[24:25], v[16:17] op_sel:[1,1,0] op_sel_hi:[0,1,1] neg_lo:[1,0,0]
v_cvt_pk_bf16_f32 v0, v20, v21
v_cvt_pk_bf16_f32 v1, v16, v17
v_pk_mul_f32 v[28:29], v[20:21], v[24:25] op_sel:[0,0] op_sel_hi:[1,0]
v_pk_mul_f32 v[30:31], v[16:17], v[24:25] op_sel:[0,0] op_sel_hi:[1,0]
ds_write_addtid_b32 v0 offset:51600
ds_write_addtid_b32 v1 offset:49536
v_pk_fma_f32 v[28:29], v[20:21], v[24:25], v[28:29] op_sel:[1,1,0] op_sel_hi:[0,1,1] neg_lo:[1,0,0]
v_pk_fma_f32 v[30:31], v[16:17], v[24:25], v[30:31] op_sel:[1,1,0] op_sel_hi:[0,1,1] neg_lo:[1,0,0]
v_cvt_pk_bf16_f32 v13, v28, v29
v_cvt_pk_bf16_f32 v3, v30, v31
v_pk_mul_f32 v[14:15], v[28:29], v[24:25] op_sel:[0,0] op_sel_hi:[1,0]
v_pk_mul_f32 v[26:27], v[30:31], v[24:25] op_sel:[0,0] op_sel_hi:[1,0]
ds_write_addtid_b32 v13 offset:55728
ds_write_addtid_b32 v3 offset:53664
v_pk_fma_f32 v[14:15], v[28:29], v[24:25], v[14:15] op_sel:[1,1,0] op_sel_hi:[0,1,1] neg_lo:[1,0,0]
v_pk_fma_f32 v[26:27], v[30:31], v[24:25], v[26:27] op_sel:[1,1,0] op_sel_hi:[0,1,1] neg_lo:[1,0,0]
v_cvt_pk_bf16_f32 v10, v14, v15
v_cvt_pk_bf16_f32 v0, v26, v27
v_pk_mul_f32 v[50:51], v[14:15], v[24:25] op_sel:[0,0] op_sel_hi:[1,0]
v_pk_mul_f32 v[20:21], v[26:27], v[24:25] op_sel:[0,0] op_sel_hi:[1,0]
ds_write_addtid_b32 v10 offset:59856
ds_write_addtid_b32 v0 offset:57792
v_pk_fma_f32 v[50:51], v[14:15], v[24:25], v[50:51] op_sel:[1,1,0] op_sel_hi:[0,1,1] neg_lo:[1,0,0]
v_pk_fma_f32 v[20:21], v[26:27], v[24:25], v[20:21] op_sel:[1,1,0] op_sel_hi:[0,1,1] neg_lo:[1,0,0]
v_cvt_pk_bf16_f32 v1, v20, v21
ds_write_addtid_b32 v1 offset:61920
s_mov_b32 m0, s53
v_cvt_pk_bf16_f32 v3, v22, -v23
s_setprio 1
v_pk_mul_f32 v[12:13], v[22:23], v[18:19] op_sel:[0,0] op_sel_hi:[1,0]
v_pk_fma_f32 v[12:13], v[22:23], v[18:19], v[12:13] op_sel:[1,1,0] op_sel_hi:[0,1,1] neg_lo:[1,0,0]
v_pk_mul_f32 v[28:29], v[22:23], v[32:33] op_sel:[0,0] op_sel_hi:[1,0]
ds_write_addtid_b32 v3 offset:4128
v_pk_mul_f32 v[10:11], v[22:23], v[50:51] op_sel:[0,0] op_sel_hi:[1,0]
v_pk_fma_f32 v[28:29], v[22:23], v[32:33], v[28:29] op_sel:[1,1,0] op_sel_hi:[0,1,1] neg_lo:[1,0,0]
v_pk_mul_f32 v[14:15], v[12:13], v[50:51] op_sel:[0,0] op_sel_hi:[1,0]
ds_read_b128 v[16:19], v98
v_cvt_pk_bf16_f32 v0, v28, -v29
v_pk_fma_f32 v[10:11], v[22:23], v[50:51], v[10:11] op_sel:[1,1,0] op_sel_hi:[0,1,1] neg_lo:[1,0,0]
v_pk_fma_f32 v[14:15], v[12:13], v[50:51], v[14:15] op_sel:[1,1,0] op_sel_hi:[0,1,1] neg_lo:[1,0,0]
v_pk_mul_f32 v[36:37], v[28:29], v[32:33] op_sel:[0,0] op_sel_hi:[1,0]
ds_write_addtid_b32 v0 offset:6192
v_cvt_pk_bf16_f32 v1, v10, -v11
v_pk_fma_f32 v[36:37], v[28:29], v[32:33], v[36:37] op_sel:[1,1,0] op_sel_hi:[0,1,1] neg_lo:[1,0,0]
v_cvt_pk_bf16_f32 v24, v14, -v15
v_cvt_pk_bf16_f32 v3, v36, -v37
v_pk_mul_f32 v[26:27], v[36:37], v[32:33] op_sel:[0,0] op_sel_hi:[1,0]
v_pk_mul_f32 v[30:31], v[10:11], v[50:51] op_sel:[0,0] op_sel_hi:[1,0]
ds_write_addtid_b32 v1 offset:20640
ds_read_b128 v[20:23], v98 offset:32
ds_write_addtid_b32 v3 offset:8256
ds_write_addtid_b32 v24 offset:28896
v_pk_fma_f32 v[26:27], v[36:37], v[32:33], v[26:27] op_sel:[1,1,0] op_sel_hi:[0,1,1] neg_lo:[1,0,0]
v_pk_mul_f32 v[12:13], v[14:15], v[50:51] op_sel:[0,0] op_sel_hi:[1,0]
v_cvt_pk_bf16_f32 v0, v26, -v27
v_pk_fma_f32 v[30:31], v[10:11], v[50:51], v[30:31] op_sel:[1,1,0] op_sel_hi:[0,1,1] neg_lo:[1,0,0]
v_pk_fma_f32 v[12:13], v[14:15], v[50:51], v[12:13] op_sel:[1,1,0] op_sel_hi:[0,1,1] neg_lo:[1,0,0]
v_pk_mul_f32 v[38:39], v[26:27], v[32:33] op_sel:[0,0] op_sel_hi:[1,0]
ds_write_addtid_b32 v0 offset:10320
v_cvt_pk_bf16_f32 v28, v30, -v31
v_pk_fma_f32 v[38:39], v[26:27], v[32:33], v[38:39] op_sel:[1,1,0] op_sel_hi:[0,1,1] neg_lo:[1,0,0]
v_cvt_pk_bf16_f32 v1, v12, -v13
v_cvt_pk_bf16_f32 v29, v38, -v39
ds_read_b128 v[24:27], v98 offset:64
v_pk_mul_f32 v[34:35], v[38:39], v[32:33] op_sel:[0,0] op_sel_hi:[1,0]
v_pk_mul_f32 v[40:41], v[30:31], v[50:51] op_sel:[0,0] op_sel_hi:[1,0]
s_setprio 0
ds_write_addtid_b32 v28 offset:30960
ds_write_addtid_b32 v29 offset:12384
ds_write_addtid_b32 v1 offset:35088
v_pk_fma_f32 v[34:35], v[38:39], v[32:33], v[34:35] op_sel:[1,1,0] op_sel_hi:[0,1,1] neg_lo:[1,0,0]
v_pk_mul_f32 v[10:11], v[12:13], v[50:51] op_sel:[0,0] op_sel_hi:[1,0]
v_cvt_pk_bf16_f32 v0, v34, -v35
v_pk_fma_f32 v[40:41], v[30:31], v[50:51], v[40:41] op_sel:[1,1,0] op_sel_hi:[0,1,1] neg_lo:[1,0,0]
v_pk_fma_f32 v[10:11], v[12:13], v[50:51], v[10:11] op_sel:[1,1,0] op_sel_hi:[0,1,1] neg_lo:[1,0,0]
v_pk_mul_f32 v[14:15], v[34:35], v[32:33] op_sel:[0,0] op_sel_hi:[1,0]
ds_write_addtid_b32 v0 offset:14448
ds_read_b128 v[28:31], v98 offset:96
v_cvt_pk_bf16_f32 v3, v40, -v41
v_pk_fma_f32 v[14:15], v[34:35], v[32:33], v[14:15] op_sel:[1,1,0] op_sel_hi:[0,1,1] neg_lo:[1,0,0]
v_cvt_pk_bf16_f32 v42, v10, -v11
v_cvt_pk_bf16_f32 v43, v14, -v15
v_pk_mul_f32 v[44:45], v[14:15], v[32:33] op_sel:[0,0] op_sel_hi:[1,0]
v_pk_mul_f32 v[46:47], v[40:41], v[50:51] op_sel:[0,0] op_sel_hi:[1,0]
ds_write_addtid_b32 v3 offset:37152
ds_write_addtid_b32 v43 offset:16512
ds_write_addtid_b32 v42 offset:41280
v_pk_fma_f32 v[44:45], v[14:15], v[32:33], v[44:45] op_sel:[1,1,0] op_sel_hi:[0,1,1] neg_lo:[1,0,0]
v_pk_mul_f32 v[12:13], v[10:11], v[50:51] op_sel:[0,0] op_sel_hi:[1,0]
v_cvt_pk_bf16_f32 v0, v44, -v45
v_pk_fma_f32 v[46:47], v[40:41], v[50:51], v[46:47] op_sel:[1,1,0] op_sel_hi:[0,1,1] neg_lo:[1,0,0]
ds_read_b128 v[32:35], v98 offset:128
v_pk_fma_f32 v[12:13], v[10:11], v[50:51], v[12:13] op_sel:[1,1,0] op_sel_hi:[0,1,1] neg_lo:[1,0,0]
v_pk_mul_f32 v[52:53], v[36:37], v[50:51] op_sel:[0,0] op_sel_hi:[1,0]
ds_write_addtid_b32 v0 offset:18576
v_cvt_pk_bf16_f32 v1, v46, -v47
v_pk_fma_f32 v[52:53], v[36:37], v[50:51], v[52:53] op_sel:[1,1,0] op_sel_hi:[0,1,1] neg_lo:[1,0,0]
v_cvt_pk_bf16_f32 v3, v12, -v13
v_cvt_pk_bf16_f32 v43, v52, -v53
v_pk_mul_f32 v[60:61], v[38:39], v[50:51] op_sel:[0,0] op_sel_hi:[1,0]
v_pk_mul_f32 v[62:63], v[46:47], v[50:51] op_sel:[0,0] op_sel_hi:[1,0]
ds_write_addtid_b32 v1 offset:43344
ds_write_addtid_b32 v43 offset:22704
ds_write_addtid_b32 v3 offset:45408
v_pk_fma_f32 v[60:61], v[38:39], v[50:51], v[60:61] op_sel:[1,1,0] op_sel_hi:[0,1,1] neg_lo:[1,0,0]
ds_read_b128 v[36:39], v98 offset:160
v_pk_mul_f32 v[10:11], v[12:13], v[50:51] op_sel:[0,0] op_sel_hi:[1,0]
s_setprio 3
v_cvt_pk_bf16_f32 v0, v60, -v61
v_pk_fma_f32 v[62:63], v[46:47], v[50:51], v[62:63] op_sel:[1,1,0] op_sel_hi:[0,1,1] neg_lo:[1,0,0]
s_cmp_lt_u32 s3, 4
s_cbranch_scc0 L_ul0
buffer_load_dwordx4 v[52:55], v96, s[40:43], s32 offen
buffer_load_dwordx4 v[56:59], v96, s[40:43], s32 offen offset:1152
L_ul0:
v_pk_fma_f32 v[10:11], v[12:13], v[50:51], v[10:11] op_sel:[1,1,0] op_sel_hi:[0,1,1] neg_lo:[1,0,0]
v_pk_mul_f32 v[40:41], v[14:15], v[50:51] op_sel:[0,0] op_sel_hi:[1,0]
ds_write_addtid_b32 v0 offset:24768
v_cvt_pk_bf16_f32 v1, v62, -v63
v_pk_fma_f32 v[40:41], v[14:15], v[50:51], v[40:41] op_sel:[1,1,0] op_sel_hi:[0,1,1] neg_lo:[1,0,0]
v_cvt_pk_bf16_f32 v3, v10, -v11
v_cvt_pk_bf16_f32 v44, v40, -v41
v_pk_mul_f32 v[64:65], v[60:61], v[50:51] op_sel:[0,0] op_sel_hi:[1,0]
v_pk_mul_f32 v[66:67], v[62:63], v[50:51] op_sel:[0,0] op_sel_hi:[1,0]
ds_read_b128 v[40:43], v98 offset:192
ds_write_addtid_b32 v1 offset:47472
ds_write_addtid_b32 v44 offset:26832
ds_write_addtid_b32 v3 offset:49536
v_pk_fma_f32 v[64:65], v[60:61], v[50:51], v[64:65] op_sel:[1,1,0] op_sel_hi:[0,1,1] neg_lo:[1,0,0]
v_pk_mul_f32 v[12:13], v[10:11], v[50:51] op_sel:[0,0] op_sel_hi:[1,0]
v_cvt_pk_bf16_f32 v0, v64, -v65
v_pk_fma_f32 v[66:67], v[62:63], v[50:51], v[66:67] op_sel:[1,1,0] op_sel_hi:[0,1,1] neg_lo:[1,0,0]
v_pk_fma_f32 v[12:13], v[10:11], v[50:51], v[12:13] op_sel:[1,1,0] op_sel_hi:[0,1,1] neg_lo:[1,0,0]
v_pk_mul_f32 v[14:15], v[64:65], v[50:51] op_sel:[0,0] op_sel_hi:[1,0]
ds_write_addtid_b32 v0 offset:33024
v_cvt_pk_bf16_f32 v68, v66, -v67
v_pk_fma_f32 v[14:15], v[64:65], v[50:51], v[14:15] op_sel:[1,1,0] op_sel_hi:[0,1,1] neg_lo:[1,0,0]
v_cvt_pk_bf16_f32 v69, v12, -v13
ds_read_b128 v[44:47], v98 offset:224
v_cvt_pk_bf16_f32 v1, v14, -v15
s_cmp_ge_u32 s3, 4
s_cbranch_scc1 L_pf3
s_cmp_lt_u32 s33, 4
s_mov_b32 exec_lo, 0xffffffff
s_cselect_b32 exec_lo, 0x55555555, exec_lo
s_mov_b32 exec_hi, 0
s_cselect_b32 exec_hi, 0, exec_hi
global_load_dword v104, v[48:49], off
s_mov_b64 exec, -1
L_pf3:
v_pk_mul_f32 v[10:11], v[66:67], v[50:51] op_sel:[0,0] op_sel_hi:[1,0]
v_pk_mul_f32 v[60:61], v[12:13], v[50:51] op_sel:[0,0] op_sel_hi:[1,0]
s_setprio 2
ds_write_addtid_b32 v68 offset:51600
ds_write_addtid_b32 v1 offset:39216
ds_write_addtid_b32 v69 offset:53664
v_pk_fma_f32 v[10:11], v[66:67], v[50:51], v[10:11] op_sel:[1,1,0] op_sel_hi:[0,1,1] neg_lo:[1,0,0]
v_pk_fma_f32 v[60:61], v[12:13], v[50:51], v[60:61] op_sel:[1,1,0] op_sel_hi:[0,1,1] neg_lo:[1,0,0]
v_cvt_pk_bf16_f32 v0, v10, -v11
v_cvt_pk_bf16_f32 v3, v60, -v61
ds_write_addtid_b32 v0 offset:55728
ds_write_addtid_b32 v3 offset:57792
ds_read_b128 v[48:51], v100
ds_read_b128 v[60:63], v100 offset:32
ds_read_b128 v[64:67], v100 offset:64
ds_read_b128 v[68:71], v100 offset:96
ds_read_b128 v[72:75], v100 offset:128
ds_read_b128 v[76:79], v100 offset:160
ds_read_b128 v[80:83], v100 offset:192
ds_read_b128 v[84:87], v100 offset:224
v_and_b32 v12, 0xffff0000, v4
v_and_b32 v13, 0xffff0000, v5
v_and_b32 v10, 0xffff0000, v6
v_and_b32 v11, 0xffff0000, v7
v_and_b32 v0, 0xffff0000, v8
v_and_b32 v1, 0xffff0000, v9
v_mul_f32 v12, v2, v12
v_mul_f32 v13, v2, v13
v_mul_f32 v12, 0x3fb8aa3b, v12
v_mul_f32 v13, 0x3e22f983, v13
v_mul_f32 v3, 0x41000000, v12
v_mul_f32 v14, 0x41000000, v13
v_exp_f32 v3, v3
v_fract_f32 v14, v14
v_cos_f32 v118, v14
v_sin_f32 v119, v14
v_mul_f32 v10, v2, v10
v_mul_f32 v11, v2, v11
v_exp_f32 v4, v12
v_fract_f32 v5, v13
s_setprio 1
v_cos_f32 v120, v5
v_sin_f32 v121, v5
v_mul_f32 v118, v3, v118
v_mul_f32 v119, v3, v119
v_mul_f32 v120, v4, v120
v_mul_f32 v121, v4, v121
v_pk_mul_f32 v[122:123], v[0:1], v[10:11] op_sel:[0,0] op_sel_hi:[1,0]
v_pk_fma_f32 v[122:123], v[0:1], v[10:11], v[122:123] op_sel:[1,1,0] op_sel_hi:[0,1,1] neg_lo:[1,0,0]
s_mov_b32 m0, s52
v_pk_mul_f32 v[124:125], v[118:119], v[118:119] op_sel:[0,0] op_sel_hi:[1,0]
v_cvt_pk_bf16_f32 v2, v118, v119
v_pk_fma_f32 v[124:125], v[118:119], v[118:119], v[124:125] op_sel:[1,1,0] op_sel_hi:[0,1,1] neg_lo:[1,0,0]
v_cvt_pk_bf16_f32 v6, v124, v125
v_pk_mul_f32 v[8:9], v[124:125], v[124:125] op_sel:[0,0] op_sel_hi:[1,0]
ds_write_addtid_b32 v2
v_pk_mul_f32 v[12:13], v[118:119], v[124:125] op_sel:[0,0] op_sel_hi:[1,0]
s_cmp_lt_u32 s3, 4
s_cbranch_scc0 L_ul1
buffer_load_dwordx4 v[88:91], v96, s[40:43], s32 offen offset:2304
buffer_load_dwordx4 v[92:95], v96, s[40:43], s32 offen offset:3456
L_ul1:
ds_write_addtid_b32 v6 offset:2064
v_pk_fma_f32 v[8:9], v[124:125], v[124:125], v[8:9] op_sel:[1,1,0] op_sel_hi:[0,1,1] neg_lo:[1,0,0]
v_pk_fma_f32 v[12:13], v[118:119], v[124:125], v[12:13] op_sel:[1,1,0] op_sel_hi:[0,1,1] neg_lo:[1,0,0]
v_cvt_pk_bf16_f32 v0, v8, v9
v_cvt_pk_bf16_f32 v1, v12, v13
v_pk_mul_f32 v[4:5], v[8:9], v[124:125] op_sel:[0,0] op_sel_hi:[1,0]
v_pk_mul_f32 v[10:11], v[12:13], v[124:125] op_sel:[0,0] op_sel_hi:[1,0]
ds_write_addtid_b32 v0 offset:6192
ds_write_addtid_b32 v1 offset:4128
v_pk_fma_f32 v[4:5], v[8:9], v[124:125], v[4:5] op_sel:[1,1,0] op_sel_hi:[0,1,1] neg_lo:[1,0,0]
v_pk_fma_f32 v[10:11], v[12:13], v[124:125], v[10:11] op_sel:[1,1,0] op_sel_hi:[0,1,1] neg_lo:[1,0,0]
v_cvt_pk_bf16_f32 v2, v4, v5
v_cvt_pk_bf16_f32 v3, v10, v11
v_pk_mul_f32 v[6:7], v[4:5], v[124:125] op_sel:[0,0] op_sel_hi:[1,0]
v_pk_mul_f32 v[14:15], v[10:11], v[124:125] op_sel:[0,0] op_sel_hi:[1,0]
s_setprio 0
ds_write_addtid_b32 v2 offset:10320
ds_write_addtid_b32 v3 offset:8256
v_pk_fma_f32 v[6:7], v[4:5], v[124:125], v[6:7] op_sel:[1,1,0] op_sel_hi:[0,1,1] neg_lo:[1,0,0]
v_pk_fma_f32 v[14:15], v[10:11], v[124:125], v[14:15] op_sel:[1,1,0] op_sel_hi:[0,1,1] neg_lo:[1,0,0]
v_cvt_pk_bf16_f32 v0, v6, v7
v_cvt_pk_bf16_f32 v1, v14, v15
v_pk_mul_f32 v[126:127], v[6:7], v[124:125] op_sel:[0,0] op_sel_hi:[1,0]
v_pk_mul_f32 v[128:129], v[14:15], v[124:125] op_sel:[0,0] op_sel_hi:[1,0]
ds_write_addtid_b32 v0 offset:14448
ds_write_addtid_b32 v1 offset:12384
v_pk_fma_f32 v[126:127], v[6:7], v[124:125], v[126:127] op_sel:[1,1,0] op_sel_hi:[0,1,1] neg_lo:[1,0,0]
v_pk_fma_f32 v[128:129], v[14:15], v[124:125], v[128:129] op_sel:[1,1,0] op_sel_hi:[0,1,1] neg_lo:[1,0,0]
v_cvt_pk_bf16_f32 v8, v126, v127
v_cvt_pk_bf16_f32 v117, v128, v129
v_pk_mul_f32 v[130:131], v[126:127], v[124:125] op_sel:[0,0] op_sel_hi:[1,0]
v_pk_mul_f32 v[132:133], v[128:129], v[124:125] op_sel:[0,0] op_sel_hi:[1,0]
ds_write_addtid_b32 v8 offset:18576
s_waitcnt lgkmcnt(14)
v_mfma_f32_32x32x16_bf16 v[0:15], v[48:51], v[16:19], 0
v_mfma_f32_32x32x16_bf16 v[0:15], v[60:63], v[20:23], v[0:15]
v_mfma_f32_32x32x16_bf16 v[0:15], v[64:67], v[24:27], v[0:15]
s_waitcnt lgkmcnt(13)
v_mfma_f32_32x32x16_bf16 v[0:15], v[68:71], v[28:31], v[0:15]
s_waitcnt lgkmcnt(0)
v_mfma_f32_32x32x16_bf16 v[0:15], v[72:75], v[32:35], v[0:15]
v_mfma_f32_32x32x16_bf16 v[0:15], v[76:79], v[36:39], v[0:15]
v_mfma_f32_32x32x16_bf16 v[0:15], v[80:83], v[40:43], v[0:15]
v_mfma_f32_32x32x16_bf16 v[0:15], v[84:87], v[44:47], v[0:15]
ds_write_addtid_b32 v117 offset:16512
v_pk_fma_f32 v[130:131], v[126:127], v[124:125], v[130:131] op_sel:[1,1,0] op_sel_hi:[0,1,1] neg_lo:[1,0,0]
s_setprio 3
v_pk_fma_f32 v[132:133], v[128:129], v[124:125], v[132:133] op_sel:[1,1,0] op_sel_hi:[0,1,1] neg_lo:[1,0,0]
v_cvt_pk_bf16_f32 v134, v130, v131
v_cvt_pk_bf16_f32 v16, v132, v133
v_pk_mul_f32 v[18:19], v[130:131], v[124:125] op_sel:[0,0] op_sel_hi:[1,0]
v_pk_mul_f32 v[20:21], v[132:133], v[124:125] op_sel:[0,0] op_sel_hi:[1,0]
ds_write_addtid_b32 v134 offset:22704
ds_write_addtid_b32 v16 offset:20640
v_pk_fma_f32 v[18:19], v[130:131], v[124:125], v[18:19] op_sel:[1,1,0] op_sel_hi:[0,1,1] neg_lo:[1,0,0]
v_pk_fma_f32 v[20:21], v[132:133], v[124:125], v[20:21] op_sel:[1,1,0] op_sel_hi:[0,1,1] neg_lo:[1,0,0]
v_cvt_pk_bf16_f32 v17, v18, v19
v_cvt_pk_bf16_f32 v22, v20, v21
v_pk_mul_f32 v[24:25], v[18:19], v[124:125] op_sel:[0,0] op_sel_hi:[1,0]
v_pk_mul_f32 v[26:27], v[20:21], v[124:125] op_sel:[0,0] op_sel_hi:[1,0]
ds_write_addtid_b32 v17 offset:26832
ds_write_addtid_b32 v22 offset:24768
v_pk_fma_f32 v[24:25], v[18:19], v[124:125], v[24:25] op_sel:[1,1,0] op_sel_hi:[0,1,1] neg_lo:[1,0,0]
v_pk_fma_f32 v[26:27], v[20:21], v[124:125], v[26:27] op_sel:[1,1,0] op_sel_hi:[0,1,1] neg_lo:[1,0,0]
v_cvt_pk_bf16_f32 v23, v24, v25
v_cvt_pk_bf16_f32 v28, v26, v27
v_pk_mul_f32 v[30:31], v[24:25], v[124:125] op_sel:[0,0] op_sel_hi:[1,0]
v_pk_mul_f32 v[32:33], v[26:27], v[124:125] op_sel:[0,0] op_sel_hi:[1,0]
ds_write_addtid_b32 v23 offset:30960
ds_write_addtid_b32 v28 offset:28896
v_pk_fma_f32 v[30:31], v[24:25], v[124:125], v[30:31] op_sel:[1,1,0] op_sel_hi:[0,1,1] neg_lo:[1,0,0]
v_pk_fma_f32 v[32:33], v[26:27], v[124:125], v[32:33] op_sel:[1,1,0] op_sel_hi:[0,1,1] neg_lo:[1,0,0]
v_cvt_pk_bf16_f32 v16, v30, v31
v_cvt_pk_bf16_f32 v17, v32, v33
v_pk_mul_f32 v[34:35], v[30:31], v[124:125] op_sel:[0,0] op_sel_hi:[1,0]
v_pk_mul_f32 v[18:19], v[32:33], v[124:125] op_sel:[0,0] op_sel_hi:[1,0]
ds_write_addtid_b32 v16 offset:35088
ds_write_addtid_b32 v17 offset:33024
v_pk_fma_f32 v[34:35], v[30:31], v[124:125], v[34:35] op_sel:[1,1,0] op_sel_hi:[0,1,1] neg_lo:[1,0,0]
v_pk_fma_f32 v[18:19], v[32:33], v[124:125], v[18:19] op_sel:[1,1,0] op_sel_hi:[0,1,1] neg_lo:[1,0,0]
v_cvt_pk_bf16_f32 v20, v34, v35
v_cvt_pk_bf16_f32 v21, v18, v19
v_pk_mul_f32 v[22:23], v[34:35], v[124:125] op_sel:[0,0] op_sel_hi:[1,0]
s_setprio 2
v_pk_mul_f32 v[24:25], v[18:19], v[124:125] op_sel:[0,0] op_sel_hi:[1,0]
ds_write_addtid_b32 v20 offset:39216
ds_write_addtid_b32 v21 offset:37152
v_pk_fma_f32 v[22:23], v[34:35], v[124:125], v[22:23] op_sel:[1,1,0] op_sel_hi:[0,1,1] neg_lo:[1,0,0]
v_pk_fma_f32 v[24:25], v[18:19], v[124:125], v[24:25] op_sel:[1,1,0] op_sel_hi:[0,1,1] neg_lo:[1,0,0]
v_cvt_pk_bf16_f32 v16, v22, v23
v_cvt_pk_bf16_f32 v17, v24, v25
v_pk_mul_f32 v[26:27], v[22:23], v[124:125] op_sel:[0,0] op_sel_hi:[1,0]
v_pk_mul_f32 v[28:29], v[24:25], v[124:125] op_sel:[0,0] op_sel_hi:[1,0]
ds_write_addtid_b32 v16 offset:43344
ds_write_addtid_b32 v17 offset:41280
v_pk_fma_f32 v[26:27], v[22:23], v[124:125], v[26:27] op_sel:[1,1,0] op_sel_hi:[0,1,1] neg_lo:[1,0,0]
v_pk_fma_f32 v[28:29], v[24:25], v[124:125], v[28:29] op_sel:[1,1,0] op_sel_hi:[0,1,1] neg_lo:[1,0,0]
v_cvt_pk_bf16_f32 v30, v26, v27
v_cvt_pk_bf16_f32 v20, v28, v29
v_pk_mul_f32 v[32:33], v[26:27], v[124:125] op_sel:[0,0] op_sel_hi:[1,0]
v_pk_mul_f32 v[34:35], v[28:29], v[124:125] op_sel:[0,0] op_sel_hi:[1,0]
ds_write_addtid_b32 v30 offset:47472
ds_write_addtid_b32 v20 offset:45408
v_pk_fma_f32 v[32:33], v[26:27], v[124:125], v[32:33] op_sel:[1,1,0] op_sel_hi:[0,1,1] neg_lo:[1,0,0]
v_pk_fma_f32 v[34:35], v[28:29], v[124:125], v[34:35] op_sel:[1,1,0] op_sel_hi:[0,1,1] neg_lo:[1,0,0]
v_cvt_pk_bf16_f32 v18, v32, v33
v_cvt_pk_bf16_f32 v16, v34, v35
v_pk_mul_f32 v[36:37], v[32:33], v[124:125] op_sel:[0,0] op_sel_hi:[1,0]
v_pk_mul_f32 v[22:23], v[34:35], v[124:125] op_sel:[0,0] op_sel_hi:[1,0]
ds_write_addtid_b32 v18 offset:51600
ds_write_addtid_b32 v16 offset:49536
v_pk_fma_f32 v[36:37], v[32:33], v[124:125], v[36:37] op_sel:[1,1,0] op_sel_hi:[0,1,1] neg_lo:[1,0,0]
v_pk_fma_f32 v[22:23], v[34:35], v[124:125], v[22:23] op_sel:[1,1,0] op_sel_hi:[0,1,1] neg_lo:[1,0,0]
v_cvt_pk_bf16_f32 v17, v36, v37
v_cvt_pk_bf16_f32 v19, v22, v23
v_pk_mul_f32 v[20:21], v[36:37], v[124:125] op_sel:[0,0] op_sel_hi:[1,0]
v_pk_mul_f32 v[24:25], v[22:23], v[124:125] op_sel:[0,0] op_sel_hi:[1,0]
ds_write_addtid_b32 v17 offset:55728
ds_write_addtid_b32 v19 offset:53664
v_pk_fma_f32 v[20:21], v[36:37], v[124:125], v[20:21] op_sel:[1,1,0] op_sel_hi:[0,1,1] neg_lo:[1,0,0]
v_pk_fma_f32 v[24:25], v[22:23], v[124:125], v[24:25] op_sel:[1,1,0] op_sel_hi:[0,1,1] neg_lo:[1,0,0]
s_setprio 1
v_cvt_pk_bf16_f32 v18, v20, v21
v_cvt_pk_bf16_f32 v16, v24, v25
v_pk_mul_f32 v[48:49], v[20:21], v[124:125] op_sel:[0,0] op_sel_hi:[1,0]
v_pk_mul_f32 v[26:27], v[24:25], v[124:125] op_sel:[0,0] op_sel_hi:[1,0]
ds_write_addtid_b32 v18 offset:59856
ds_write_addtid_b32 v16 offset:57792
v_pk_fma_f32 v[48:49], v[20:21], v[124:125], v[48:49] op_sel:[1,1,0] op_sel_hi:[0,1,1] neg_lo:[1,0,0]
v_pk_fma_f32 v[26:27], v[24:25], v[124:125], v[26:27] op_sel:[1,1,0] op_sel_hi:[0,1,1] neg_lo:[1,0,0]
v_cvt_pk_bf16_f32 v17, v26, v27
ds_write_addtid_b32 v17 offset:61920
s_mov_b32 m0, s53
v_cvt_pk_bf16_f32 v19, v122, -v123
v_pk_mul_f32 v[22:23], v[122:123], v[118:119] op_sel:[0,0] op_sel_hi:[1,0]
v_pk_fma_f32 v[22:23], v[122:123], v[118:119], v[22:23] op_sel:[1,1,0] op_sel_hi:[0,1,1] neg_lo:[1,0,0]
v_pk_mul_f32 v[28:29], v[122:123], v[120:121] op_sel:[0,0] op_sel_hi:[1,0]
ds_write_addtid_b32 v19 offset:4128
v_pk_mul_f32 v[30:31], v[122:123], v[48:49] op_sel:[0,0] op_sel_hi:[1,0]
v_pk_fma_f32 v[28:29], v[122:123], v[120:121], v[28:29] op_sel:[1,1,0] op_sel_hi:[0,1,1] neg_lo:[1,0,0]
v_pk_mul_f32 v[32:33], v[22:23], v[48:49] op_sel:[0,0] op_sel_hi:[1,0]
ds_read_b128 v[16:19], v98
v_cvt_pk_bf16_f32 v20, v28, -v29
v_pk_fma_f32 v[30:31], v[122:123], v[48:49], v[30:31] op_sel:[1,1,0] op_sel_hi:[0,1,1] neg_lo:[1,0,0]
v_pk_fma_f32 v[32:33], v[22:23], v[48:49], v[32:33] op_sel:[1,1,0] op_sel_hi:[0,1,1] neg_lo:[1,0,0]
v_pk_mul_f32 v[36:37], v[28:29], v[120:121] op_sel:[0,0] op_sel_hi:[1,0]
ds_write_addtid_b32 v20 offset:6192
v_cvt_pk_bf16_f32 v21, v30, -v31
v_pk_fma_f32 v[36:37], v[28:29], v[120:121], v[36:37] op_sel:[1,1,0] op_sel_hi:[0,1,1] neg_lo:[1,0,0]
v_cvt_pk_bf16_f32 v24, v32, -v33
v_cvt_pk_bf16_f32 v25, v36, -v37
v_pk_mul_f32 v[26:27], v[36:37], v[120:121] op_sel:[0,0] op_sel_hi:[1,0]
v_pk_mul_f32 v[34:35], v[30:31], v[48:49] op_sel:[0,0] op_sel_hi:[1,0]
ds_write_addtid_b32 v21 offset:20640
ds_read_b128 v[20:23], v98 offset:32
ds_write_addtid_b32 v25 offset:8256
ds_write_addtid_b32 v24 offset:28896
v_pk_fma_f32 v[26:27], v[36:37], v[120:121], v[26:27] op_sel:[1,1,0] op_sel_hi:[0,1,1] neg_lo:[1,0,0]
v_pk_mul_f32 v[38:39], v[32:33], v[48:49] op_sel:[0,0] op_sel_hi:[1,0]
v_cvt_pk_bf16_f32 v40, v26, -v27
s_setprio 0
v_pk_fma_f32 v[34:35], v[30:31], v[48:49], v[34:35] op_sel:[1,1,0] op_sel_hi:[0,1,1] neg_lo:[1,0,0]
v_pk_fma_f32 v[38:39], v[32:33], v[48:49], v[38:39] op_sel:[1,1,0] op_sel_hi:[0,1,1] neg_lo:[1,0,0]
v_pk_mul_f32 v[42:43], v[26:27], v[120:121] op_sel:[0,0] op_sel_hi:[1,0]
ds_write_addtid_b32 v40 offset:10320
v_cvt_pk_bf16_f32 v28, v34, -v35
v_pk_fma_f32 v[42:43], v[26:27], v[120:121], v[42:43] op_sel:[1,1,0] op_sel_hi:[0,1,1] neg_lo:[1,0,0]
v_cvt_pk_bf16_f32 v29, v38, -v39
v_cvt_pk_bf16_f32 v41, v42, -v43
ds_read_b128 v[24:27], v98 offset:64
v_pk_mul_f32 v[44:45], v[42:43], v[120:121] op_sel:[0,0] op_sel_hi:[1,0]
v_pk_mul_f32 v[46:47], v[34:35], v[48:49] op_sel:[0,0] op_sel_hi:[1,0]
ds_write_addtid_b32 v28 offset:30960
ds_write_addtid_b32 v41 offset:12384
ds_write_addtid_b32 v29 offset:35088
v_pk_fma_f32 v[44:45], v[42:43], v[120:121], v[44:45] op_sel:[1,1,0] op_sel_hi:[0,1,1] neg_lo:[1,0,0]
s_cmp_lt_u32 s3, 4
s_cbranch_scc1 L_ul2
buffer_load_dwordx4 v[52:55], v96, s[40:43], s32 offen
buffer_load_dwordx4 v[56:59], v96, s[40:43], s32 offen offset:1152
L_ul2:
v_pk_mul_f32 v[50:51], v[38:39], v[48:49] op_sel:[0,0] op_sel_hi:[1,0]
v_cvt_pk_bf16_f32 v30, v44, -v45
v_pk_fma_f32 v[46:47], v[34:35], v[48:49], v[46:47] op_sel:[1,1,0] op_sel_hi:[0,1,1] neg_lo:[1,0,0]
v_pk_fma_f32 v[50:51], v[38:39], v[48:49], v[50:51] op_sel:[1,1,0] op_sel_hi:[0,1,1] neg_lo:[1,0,0]
v_pk_mul_f32 v[60:61], v[44:45], v[120:121] op_sel:[0,0] op_sel_hi:[1,0]
ds_write_addtid_b32 v30 offset:14448
ds_read_b128 v[28:31], v98 offset:96
v_cvt_pk_bf16_f32 v32, v46, -v47
v_pk_fma_f32 v[60:61], v[44:45], v[120:121], v[60:61] op_sel:[1,1,0] op_sel_hi:[0,1,1] neg_lo:[1,0,0]
v_cvt_pk_bf16_f32 v33, v50, -v51
v_cvt_pk_bf16_f32 v40, v60, -v61
v_pk_mul_f32 v[62:63], v[60:61], v[120:121] op_sel:[0,0] op_sel_hi:[1,0]
v_pk_mul_f32 v[64:65], v[46:47], v[48:49] op_sel:[0,0] op_sel_hi:[1,0]
ds_write_addtid_b32 v32 offset:37152
ds_write_addtid_b32 v40 offset:16512
ds_write_addtid_b32 v33 offset:41280
v_pk_fma_f32 v[62:63], v[60:61], v[120:121], v[62:63] op_sel:[1,1,0] op_sel_hi:[0,1,1] neg_lo:[1,0,0]
v_pk_mul_f32 v[66:67], v[50:51], v[48:49] op_sel:[0,0] op_sel_hi:[1,0]
v_cvt_pk_bf16_f32 v38, v62, -v63
v_pk_fma_f32 v[64:65], v[46:47], v[48:49], v[64:65] op_sel:[1,1,0] op_sel_hi:[0,1,1] neg_lo:[1,0,0]
s_setprio 3
ds_read_b128 v[32:35], v98 offset:128
v_pk_fma_f32 v[66:67], v[50:51], v[48:49], v[66:67] op_sel:[1,1,0] op_sel_hi:[0,1,1] neg_lo:[1,0,0]
v_pk_mul_f32 v[44:45], v[36:37], v[48:49] op_sel:[0,0] op_sel_hi:[1,0]
ds_write_addtid_b32 v38 offset:18576
v_cvt_pk_bf16_f32 v39, v64, -v65
v_pk_fma_f32 v[44:45], v[36:37], v[48:49], v[44:45] op_sel:[1,1,0] op_sel_hi:[0,1,1] neg_lo:[1,0,0]
v_cvt_pk_bf16_f32 v40, v66, -v67
v_cvt_pk_bf16_f32 v41, v44, -v45
v_pk_mul_f32 v[68:69], v[42:43], v[48:49] op_sel:[0,0] op_sel_hi:[1,0]
v_pk_mul_f32 v[70:71], v[64:65], v[48:49] op_sel:[0,0] op_sel_hi:[1,0]
ds_write_addtid_b32 v39 offset:43344
ds_write_addtid_b32 v41 offset:22704
ds_write_addtid_b32 v40 offset:45408
v_pk_fma_f32 v[68:69], v[42:43], v[48:49], v[68:69] op_sel:[1,1,0] op_sel_hi:[0,1,1] neg_lo:[1,0,0]
ds_read_b128 v[36:39], v98 offset:160
v_pk_mul_f32 v[46:47], v[66:67], v[48:49] op_sel:[0,0] op_sel_hi:[1,0]
v_cvt_pk_bf16_f32 v50, v68, -v69
v_pk_fma_f32 v[70:71], v[64:65], v[48:49], v[70:71] op_sel:[1,1,0] op_sel_hi:[0,1,1] neg_lo:[1,0,0]
v_pk_fma_f32 v[46:47], v[66:67], v[48:49], v[46:47] op_sel:[1,1,0] op_sel_hi:[0,1,1] neg_lo:[1,0,0]
v_pk_mul_f32 v[62:63], v[60:61], v[48:49] op_sel:[0,0] op_sel_hi:[1,0]
ds_write_addtid_b32 v50 offset:24768
v_cvt_pk_bf16_f32 v44, v70, -v71
v_pk_fma_f32 v[62:63], v[60:61], v[48:49], v[62:63] op_sel:[1,1,0] op_sel_hi:[0,1,1] neg_lo:[1,0,0]
v_cvt_pk_bf16_f32 v45, v46, -v47
v_cvt_pk_bf16_f32 v51, v62, -v63
v_pk_mul_f32 v[72:73], v[68:69], v[48:49] op_sel:[0,0] op_sel_hi:[1,0]
v_pk_mul_f32 v[74:75], v[70:71], v[48:49] op_sel:[0,0] op_sel_hi:[1,0]
ds_read_b128 v[40:43], v98 offset:192
ds_write_addtid_b32 v44 offset:47472
ds_write_addtid_b32 v51 offset:26832
ds_write_addtid_b32 v45 offset:49536
v_pk_fma_f32 v[72:73], v[68:69], v[48:49], v[72:73] op_sel:[1,1,0] op_sel_hi:[0,1,1] neg_lo:[1,0,0]
v_pk_mul_f32 v[64:65], v[46:47], v[48:49] op_sel:[0,0] op_sel_hi:[1,0]
v_cvt_pk_bf16_f32 v50, v72, -v73
v_pk_fma_f32 v[74:75], v[70:71], v[48:49], v[74:75] op_sel:[1,1,0] op_sel_hi:[0,1,1] neg_lo:[1,0,0]
v_pk_fma_f32 v[64:65], v[46:47], v[48:49], v[64:65] op_sel:[1,1,0] op_sel_hi:[0,1,1] neg_lo:[1,0,0]
v_pk_mul_f32 v[60:61], v[72:73], v[48:49] op_sel:[0,0] op_sel_hi:[1,0]
ds_write_addtid_b32 v50 offset:33024
v_cvt_pk_bf16_f32 v62, v74, -v75
s_setprio 2
v_pk_fma_f32 v[60:61], v[72:73], v[48:49], v[60:61] op_sel:[1,1,0] op_sel_hi:[0,1,1] neg_lo:[1,0,0]
v_cvt_pk_bf16_f32 v63, v64, -v65
ds_read_b128 v[44:47], v98 offset:224
v_cvt_pk_bf16_f32 v51, v60, -v61
v_pk_mul_f32 v[66:67], v[74:75], v[48:49] op_sel:[0,0] op_sel_hi:[1,0]
v_pk_mul_f32 v[68:69], v[64:65], v[48:49] op_sel:[0,0] op_sel_hi:[1,0]
ds_write_addtid_b32 v62 offset:51600
ds_write_addtid_b32 v51 offset:39216
ds_write_addtid_b32 v63 offset:53664
v_pk_fma_f32 v[66:67], v[74:75], v[48:49], v[66:67] op_sel:[1,1,0] op_sel_hi:[0,1,1] neg_lo:[1,0,0]
v_pk_fma_f32 v[68:69], v[64:65], v[48:49], v[68:69] op_sel:[1,1,0] op_sel_hi:[0,1,1] neg_lo:[1,0,0]
v_cvt_pk_bf16_f32 v50, v66, -v67
v_cvt_pk_bf16_f32 v70, v68, -v69
ds_write_addtid_b32 v50 offset:55728
ds_write_addtid_b32 v70 offset:57792
ds_read_b128 v[76:79], v100
ds_read_b128 v[80:83], v100 offset:32
s_cmp_lt_u32 s3, 4
s_cbranch_scc1 L_ul3
buffer_load_dwordx4 v[88:91], v96, s[40:43], s32 offen offset:2304
buffer_load_dwordx4 v[92:95], v96, s[40:43], s32 offen offset:3456
L_ul3:
ds_read_b128 v[60:63], v100 offset:64
ds_read_b128 v[72:75], v100 offset:96
ds_read_b128 v[84:87], v100 offset:128
ds_read_b128 v[64:67], v100 offset:160
ds_read_b128 v[118:121], v100 offset:192
ds_read_b128 v[48:51], v100 offset:224
s_cmp_eq_u32 s31, 1
s_cbranch_scc1 L_Ahi
s_waitcnt lgkmcnt(7)
v_mfma_f32_32x32x16_bf16 v[0:15], v[76:79], v[16:19], v[0:15]
s_waitcnt lgkmcnt(6)
v_mfma_f32_32x32x16_bf16 v[0:15], v[80:83], v[20:23], v[0:15]
s_waitcnt lgkmcnt(5)
v_mfma_f32_32x32x16_bf16 v[0:15], v[60:63], v[24:27], v[0:15]
s_waitcnt lgkmcnt(4)
v_mfma_f32_32x32x16_bf16 v[0:15], v[72:75], v[28:31], v[0:15]
s_cmp_lt_u32 s3, 4
s_cbranch_scc0 L_u00
s_waitcnt vmcnt(0)
v_perm_b32 v68, v56, v52, s50
v_perm_b32 v69, v92, v88, s50
ds_write_b64 v107, v[68:69]
v_perm_b32 v122, v56, v52, s51
v_perm_b32 v123, v92, v88, s51
ds_write_b64 v107, v[122:123] offset:4256
v_perm_b32 v124, v57, v53, s50
v_perm_b32 v125, v93, v89, s50
ds_write_b64 v107, v[124:125] offset:8512
v_perm_b32 v126, v57, v53, s51
v_perm_b32 v127, v93, v89, s51
ds_write_b64 v107, v[126:127] offset:12768
v_perm_b32 v128, v58, v54, s50
v_perm_b32 v129, v94, v90, s50
ds_write_b64 v107, v[128:129] offset:17024
v_perm_b32 v130, v58, v54, s51
v_perm_b32 v131, v94, v90, s51
ds_write_b64 v107, v[130:131] offset:21280
v_perm_b32 v132, v59, v55, s50
v_perm_b32 v133, v95, v91, s50
ds_write_b64 v107, v[132:133] offset:25536
v_perm_b32 v134, v59, v55, s51
v_perm_b32 v135, v95, v91, s51
ds_write_b64 v107, v[134:135] offset:29792
v_mov_b32 v104, v104
L_u00:
s_waitcnt lgkmcnt(0)
v_mfma_f32_32x32x16_bf16 v[0:15], v[84:87], v[32:35], v[0:15]
v_mfma_f32_32x32x16_bf16 v[0:15], v[64:67], v[36:39], v[0:15]
v_mfma_f32_32x32x16_bf16 v[0:15], v[118:121], v[40:43], v[0:15]
v_mfma_f32_32x32x16_bf16 v[0:15], v[48:51], v[44:47], v[0:15]
s_nop 11
v_add_f32 v16, v0, v116
v_cvt_pk_bf16_f32 v19, v2, v3
v_cvt_pk_bf16_f32 v18, v16, v1
v_cvt_pk_bf16_f32 v20, v4, v5
v_cvt_pk_bf16_f32 v21, v6, v7
s_waitcnt lgkmcnt(0)
s_barrier
s_setprio 3
s_mov_b32 m0, s38
ds_write_b64 v101, v[18:19]
s_mov_b64 exec, 0xffffff
ds_write_b32 v97, v115
s_mov_b64 exec, -1
ds_write_b64 v101, v[20:21] offset:512
ds_read_b64_tr_b16 v[70:71], v105 offset:128
ds_read_b64_tr_b16 v[72:73], v105
ds_read_b64_tr_b16 v[16:17], v106
ds_read_b64_tr_b16 v[18:19], v106 offset:128
ds_read_b64_tr_b16 v[20:21], v106 offset:256
ds_read_b64_tr_b16 v[22:23], v106 offset:384
ds_read_b64_tr_b16 v[24:25], v106 offset:512
ds_read_b64_tr_b16 v[74:75], v105 offset:384
ds_read_b64_tr_b16 v[76:77], v105 offset:256
ds_read_b64_tr_b16 v[78:79], v105 offset:640
ds_read_b64_tr_b16 v[80:81], v105 offset:512
s_waitcnt lgkmcnt(7)
v_mfma_f32_16x16x32_bf16 v[60:63], v[70:73], v[16:19], 0
v_cvt_pk_bf16_f32 v34, v8, v8
v_cvt_pk_bf16_f32 v35, v8, v9
ds_read_b64_tr_b16 v[26:27], v106 offset:640
ds_read_b64_tr_b16 v[28:29], v106 offset:768
s_waitcnt lgkmcnt(8)
v_mfma_f32_16x16x32_bf16 v[64:67], v[70:73], v[18:21], 0
v_cvt_pk_bf16_f32 v36, v9, v9
v_cvt_pk_bf16_f32 v37, v10, v10
ds_write_b128 v102, v[34:37] offset:1024
ds_read_b64_tr_b16 v[82:83], v105 offset:896
s_waitcnt lgkmcnt(6)
v_mfma_f32_16x16x32_bf16 v[116:119], v[74:77], v[16:19], 0
v_cvt_pk_bf16_f32 v96, v12, v12
v_cvt_pk_bf16_f32 v99, v13, v13
ds_read_b64_tr_b16 v[84:85], v105 offset:768
ds_read_b64_tr_b16 v[30:31], v106 offset:896
v_mfma_f32_16x16x32_bf16 v[116:119], v[70:73], v[20:23], v[116:119]
v_add_f32_dpp v86, v63, v62 wave_shr:1 row_mask:0xf bank_mask:0xf bound_ctrl:0
v_cvt_pk_bf16_f32 v97, v12, v12
ds_read_b64_tr_b16 v[32:33], v106 offset:1024
ds_read_b64_tr_b16 v[34:35], v106 offset:1024
v_mfma_f32_16x16x32_bf16 v[136:139], v[74:77], v[18:21], 0
v_add_f32_dpp v87, v86, v61 wave_shr:1 row_mask:0xf bank_mask:0xf bound_ctrl:0
v_perm_b32 v98, v99, v96, v111
ds_write_b128 v103, v[96:99] offset:2048
ds_read_b64_tr_b16 v[36:37], v106 offset:1152
v_mfma_f32_16x16x32_bf16 v[136:139], v[70:73], v[22:25], v[136:139]
v_add_f32_dpp v115, v87, v60 wave_shr:1 row_mask:0xf bank_mask:0xf bound_ctrl:0
v_cvt_pk_bf16_f32 v140, v14, v14
ds_read_b64_tr_b16 v[38:39], v106 offset:1280
ds_read_b64_tr_b16 v[40:41], v106 offset:1408
s_waitcnt lgkmcnt(8)
v_mfma_f32_16x16x32_bf16 v[144:147], v[78:81], v[16:19], 0
v_cvt_pk_bf16_f32 v143, v15, v15
v_cvt_pk_bf16_f32 v141, v14, v14
v_mfma_f32_16x16x32_bf16 v[144:147], v[74:77], v[20:23], v[144:147]
v_perm_b32 v142, v143, v140, v111
ds_write_b128 v103, v[140:143] offset:2560
v_add_f32_dpp v120, v63, v66 wave_ror:1 row_mask:0x1 bank_mask:0x1
ds_read_b64_tr_b16 v[96:97], v105 offset:1152
v_mfma_f32_16x16x32_bf16 v[144:147], v[70:73], v[24:27], v[144:147]
v_add_f32_dpp v121, v86, v65 wave_ror:1 row_mask:0x1 bank_mask:0x1
s_setprio 2
v_add_f32_dpp v120, v67, v66 wave_shr:1 row_mask:0xf bank_mask:0xf
ds_read_b64_tr_b16 v[98:99], v105 offset:1024
ds_read_b64_tr_b16 v[100:101], v105 offset:1408
v_mfma_f32_16x16x32_bf16 v[60:63], v[78:81], v[18:21], 0
v_add_f32_dpp v148, v87, v64 wave_ror:1 row_mask:0x1 bank_mask:0x1
v_add_f32_dpp v121, v120, v65 wave_shr:1 row_mask:0xf bank_mask:0xf
ds_read_b64_tr_b16 v[102:103], v105 offset:1280
v_mfma_f32_16x16x32_bf16 v[60:63], v[74:77], v[22:25], v[60:63]
v_add_f32_dpp v148, v121, v64 wave_shr:1 row_mask:0xf bank_mask:0xf
v_add_f32_dpp v8, v67, v118 wave_ror:1 row_mask:0x1 bank_mask:0x1
v_mfma_f32_16x16x32_bf16 v[60:63], v[70:73], v[26:29], v[60:63]
v_add_f32_dpp v9, v120, v117 wave_ror:1 row_mask:0x1 bank_mask:0x1
v_add_f32_dpp v8, v119, v118 wave_shr:1 row_mask:0xf bank_mask:0xf
ds_read_b64_tr_b16 v[42:43], v106 offset:1536
s_waitcnt lgkmcnt(4)
v_mfma_f32_16x16x32_bf16 v[0:3], v[82:85], v[16:19], 0
v_add_f32_dpp v111, v121, v116 wave_ror:1 row_mask:0x1 bank_mask:0x1
v_add_f32_dpp v9, v8, v117 wave_shr:1 row_mask:0xf bank_mask:0xf
ds_read_b64_tr_b16 v[4:5], v105 offset:1664
ds_read_b64_tr_b16 v[6:7], v105 offset:1536
v_mfma_f32_16x16x32_bf16 v[0:3], v[78:81], v[20:23], v[0:3]
v_add_f32_dpp v111, v9, v116 wave_shr:1 row_mask:0xf bank_mask:0xf
v_add_f32_dpp v12, v119, v138 wave_ror:1 row_mask:0x1 bank_mask:0x1
v_mfma_f32_16x16x32_bf16 v[0:3], v[74:77], v[24:27], v[0:3]
v_add_f32_dpp v13, v8, v137 wave_ror:1 row_mask:0x1 bank_mask:0x1
v_add_f32_dpp v12, v139, v138 wave_shr:1 row_mask:0xf bank_mask:0xf
v_mfma_f32_16x16x32_bf16 v[0:3], v[70:73], v[28:31], v[0:3]
v_add_f32_dpp v120, v9, v136 wave_ror:1 row_mask:0x1 bank_mask:0x1
v_add_f32_dpp v13, v12, v137 wave_shr:1 row_mask:0xf bank_mask:0xf
v_mfma_f32_16x16x32_bf16 v[8:11], v[82:85], v[18:21], 0
s_nop 0
v_add_f32_dpp v120, v13, v136 wave_shr:1 row_mask:0xf bank_mask:0xf
v_add_f32_dpp v121, v139, v146 wave_ror:1 row_mask:0x1 bank_mask:0x1
v_mfma_f32_16x16x32_bf16 v[8:11], v[78:81], v[22:25], v[8:11]
v_add_f32_dpp v140, v12, v145 wave_ror:1 row_mask:0x1 bank_mask:0x1
v_add_f32_dpp v121, v147, v146 wave_shr:1 row_mask:0xf bank_mask:0xf
v_mfma_f32_16x16x32_bf16 v[8:11], v[74:77], v[26:29], v[8:11]
v_add_f32_dpp v116, v13, v144 wave_ror:1 row_mask:0x1 bank_mask:0x1
v_add_f32_dpp v140, v121, v145 wave_shr:1 row_mask:0xf bank_mask:0xf
ds_read_b64_tr_b16 v[44:45], v106 offset:1664
v_mfma_f32_16x16x32_bf16 v[8:11], v[70:73], v[30:33], v[8:11]
v_add_f32_dpp v116, v140, v144 wave_shr:1 row_mask:0xf bank_mask:0xf
v_add_f32_dpp v117, v147, v62 wave_ror:1 row_mask:0x1 bank_mask:0x1
s_waitcnt lgkmcnt(1)
v_mfma_f32_16x16x32_bf16 v[12:15], v[96:99], v[16:19], 0
s_setprio 1
s_cmp_lt_u32 s3, 4
s_cbranch_scc1 L_u10
s_waitcnt vmcnt(0)
v_perm_b32 v68, v56, v52, s50
v_perm_b32 v69, v92, v88, s50
ds_write_b64 v107, v[68:69]
v_perm_b32 v122, v56, v52, s51
v_perm_b32 v123, v92, v88, s51
ds_write_b64 v107, v[122:123] offset:4256
v_perm_b32 v124, v57, v53, s50
v_perm_b32 v125, v93, v89, s50
ds_write_b64 v107, v[124:125] offset:8512
v_perm_b32 v126, v57, v53, s51
v_perm_b32 v127, v93, v89, s51
ds_write_b64 v107, v[126:127] offset:12768
v_perm_b32 v128, v58, v54, s50
v_perm_b32 v129, v94, v90, s50
ds_write_b64 v107, v[128:129] offset:17024
v_perm_b32 v130, v58, v54, s51
v_perm_b32 v131, v94, v90, s51
ds_write_b64 v107, v[130:131] offset:21280
v_perm_b32 v132, v59, v55, s50
v_perm_b32 v133, v95, v91, s50
ds_write_b64 v107, v[132:133] offset:25536
v_perm_b32 v134, v59, v55, s51
v_perm_b32 v135, v95, v91, s51
ds_write_b64 v107, v[134:135] offset:29792
v_mov_b32 v104, v104
L_u10:
ds_write_b32 v113, v114 offset:224
v_mfma_f32_16x16x32_bf16 v[12:15], v[82:85], v[20:23], v[12:15]
v_mfma_f32_16x16x32_bf16 v[12:15], v[78:81], v[24:27], v[12:15]
v_mfma_f32_16x16x32_bf16 v[12:15], v[74:77], v[28:31], v[12:15]
v_mfma_f32_16x16x32_bf16 v[12:15], v[70:73], v[34:37], v[12:15]
v_mfma_f32_16x16x32_bf16 v[64:67], v[96:99], v[18:21], 0
ds_read_b64_tr_b16 v[46:47], v106 offset:1792
ds_read_b32 v68, v112 offset:224
v_mfma_f32_16x16x32_bf16 v[64:67], v[82:85], v[22:25], v[64:67]
ds_read_b64_tr_b16 v[86:87], v105 offset:1920
ds_read_b64_tr_b16 v[88:89], v105 offset:1792
v_mfma_f32_16x16x32_bf16 v[64:67], v[78:81], v[26:29], v[64:67]
v_mfma_f32_16x16x32_bf16 v[64:67], v[74:77], v[30:33], v[64:67]
v_add_f32_dpp v56, v121, v61 wave_ror:1 row_mask:0x1 bank_mask:0x1
v_mfma_f32_16x16x32_bf16 v[64:67], v[70:73], v[36:39], v[64:67]
v_add_f32_dpp v117, v63, v62 wave_shr:1 row_mask:0xf bank_mask:0xf
v_add_f32_dpp v57, v140, v60 wave_ror:1 row_mask:0x1 bank_mask:0x1
v_mfma_f32_16x16x32_bf16 v[52:55], v[100:103], v[16:19], 0
v_add_f32_dpp v56, v117, v61 wave_shr:1 row_mask:0xf bank_mask:0xf
s_setprio 0
v_cvt_pk_bf16_f32 v58, v115, v148
ds_write_addtid_b32 v58 offset:4352
v_mfma_f32_16x16x32_bf16 v[52:55], v[96:99], v[20:23], v[52:55]
v_add_f32_dpp v57, v56, v60 wave_shr:1 row_mask:0xf bank_mask:0xf
v_add_f32_dpp v59, v63, v2 wave_ror:1 row_mask:0x1 bank_mask:0x1
v_mfma_f32_16x16x32_bf16 v[52:55], v[82:85], v[24:27], v[52:55]
v_add_f32_dpp v69, v117, v1 wave_ror:1 row_mask:0x1 bank_mask:0x1
v_add_f32_dpp v59, v3, v2 wave_shr:1 row_mask:0xf bank_mask:0xf
v_mfma_f32_16x16x32_bf16 v[52:55], v[78:81], v[28:31], v[52:55]
v_add_f32_dpp v94, v56, v0 wave_ror:1 row_mask:0x1 bank_mask:0x1
v_add_f32_dpp v69, v59, v1 wave_shr:1 row_mask:0xf bank_mask:0xf
ds_read_b64_tr_b16 v[48:49], v106 offset:1920
v_mfma_f32_16x16x32_bf16 v[52:55], v[74:77], v[34:37], v[52:55]
v_add_f32_dpp v94, v69, v0 wave_shr:1 row_mask:0xf bank_mask:0xf
v_add_f32_dpp v58, v3, v10 wave_ror:1 row_mask:0x1 bank_mask:0x1
v_mfma_f32_16x16x32_bf16 v[52:55], v[70:73], v[38:41], v[52:55]
v_add_f32_dpp v95, v59, v9 wave_ror:1 row_mask:0x1 bank_mask:0x1
v_add_f32_dpp v58, v11, v10 wave_shr:1 row_mask:0xf bank_mask:0xf
v_mfma_f32_16x16x32_bf16 v[90:93], v[100:103], v[18:21], 0
v_add_f32_dpp v60, v69, v8 wave_ror:1 row_mask:0x1 bank_mask:0x1
v_add_f32_dpp v95, v58, v9 wave_shr:1 row_mask:0xf bank_mask:0xf
v_mfma_f32_16x16x32_bf16 v[90:93], v[96:99], v[22:25], v[90:93]
s_nop 0
v_add_f32_dpp v60, v95, v8 wave_shr:1 row_mask:0xf bank_mask:0xf
v_cvt_pk_bf16_f32 v56, v111, v120
ds_write_addtid_b32 v56 offset:4608
v_mfma_f32_16x16x32_bf16 v[90:93], v[82:85], v[26:29], v[90:93]
v_cvt_pk_bf16_f32 v61, v116, v57
ds_write_addtid_b32 v61 offset:4864
v_cvt_pk_bf16_f32 v0, v94, v60
ds_write_addtid_b32 v0 offset:5120
v_mfma_f32_16x16x32_bf16 v[90:93], v[78:81], v[30:33], v[90:93]
ds_write_b32 v113, v114
v_add_f32_dpp v59, v11, v14 wave_ror:1 row_mask:0x1 bank_mask:0x1
v_add_f32_dpp v62, v58, v13 wave_ror:1 row_mask:0x1 bank_mask:0x1
v_mfma_f32_16x16x32_bf16 v[90:93], v[74:77], v[36:39], v[90:93]
v_add_f32_dpp v59, v15, v14 wave_shr:1 row_mask:0xf bank_mask:0xf
v_add_f32_dpp v63, v95, v12 wave_ror:1 row_mask:0x1 bank_mask:0x1
v_mfma_f32_16x16x32_bf16 v[90:93], v[70:73], v[40:43], v[90:93]
v_add_f32_dpp v62, v59, v13 wave_shr:1 row_mask:0xf bank_mask:0xf
ds_read_b64_tr_b16 v[50:51], v106 offset:2048
s_waitcnt lgkmcnt(4)
v_cmp_ne_u32 vcc, 1, v68
s_cbranch_vccnz L_f8r
L_f8:
v_mfma_f32_16x16x32_bf16 v[116:119], v[4:7], v[16:19], 0
v_add_f32_dpp v63, v62, v12 wave_shr:1 row_mask:0xf bank_mask:0xf
v_add_f32_dpp v56, v15, v66 wave_ror:1 row_mask:0x1 bank_mask:0x1
ds_read_b64_tr_b16 v[0:1], v105 offset:2176
ds_read_b64_tr_b16 v[2:3], v105 offset:2048
v_mfma_f32_16x16x32_bf16 v[116:119], v[100:103], v[20:23], v[116:119]
v_add_f32_dpp v8, v59, v65 wave_ror:1 row_mask:0x1 bank_mask:0x1
v_add_f32_dpp v56, v67, v66 wave_shr:1 row_mask:0xf bank_mask:0xf
v_mfma_f32_16x16x32_bf16 v[116:119], v[96:99], v[24:27], v[116:119]
ds_read_b32 v9, v112
v_add_f32_dpp v10, v62, v64 wave_ror:1 row_mask:0x1 bank_mask:0x1
v_add_f32_dpp v8, v56, v65 wave_shr:1 row_mask:0xf bank_mask:0xf
v_mfma_f32_16x16x32_bf16 v[116:119], v[82:85], v[28:31], v[116:119]
s_nop 0
v_add_f32_dpp v10, v8, v64 wave_shr:1 row_mask:0xf bank_mask:0xf
v_add_f32_dpp v11, v67, v54 wave_ror:1 row_mask:0x1 bank_mask:0x1
v_mfma_f32_16x16x32_bf16 v[116:119], v[78:81], v[34:37], v[116:119]
v_add_f32_dpp v12, v56, v53 wave_ror:1 row_mask:0x1 bank_mask:0x1
v_add_f32_dpp v11, v55, v54 wave_shr:1 row_mask:0xf bank_mask:0xf
v_mfma_f32_16x16x32_bf16 v[116:119], v[74:77], v[38:41], v[116:119]
v_add_f32_dpp v13, v8, v52 wave_ror:1 row_mask:0x1 bank_mask:0x1
v_add_f32_dpp v12, v11, v53 wave_shr:1 row_mask:0xf bank_mask:0xf
v_mfma_f32_16x16x32_bf16 v[116:119], v[70:73], v[42:45], v[116:119]
s_nop 0
v_add_f32_dpp v13, v12, v52 wave_shr:1 row_mask:0xf bank_mask:0xf
v_cvt_pk_bf16_f32 v14, v63, v10
ds_write_addtid_b32 v14 offset:5376
v_mfma_f32_16x16x32_bf16 v[120:123], v[4:7], v[18:21], 0
v_add_f32_dpp v15, v55, v92 wave_ror:1 row_mask:0x1 bank_mask:0x1
v_add_f32_dpp v94, v11, v91 wave_ror:1 row_mask:0x1 bank_mask:0x1
v_mfma_f32_16x16x32_bf16 v[120:123], v[100:103], v[22:25], v[120:123]
s_waitcnt lgkmcnt(1)
v_cmp_ne_u32 vcc, 1, v9
s_cbranch_vccnz L_f9r
L_f9:
s_setprio 3
ds_read_b64_tr_b16 v[124:125], v109
ds_read_b64_tr_b16 v[126:127], v109 offset:35072
v_mfma_f32_16x16x32_bf16 v[120:123], v[96:99], v[26:29], v[120:123]
s_add_u32 s48, s54, 0
v_add_f32_dpp v15, v93, v92 wave_shr:1 row_mask:0xf bank_mask:0xf
v_add_f32_dpp v8, v12, v90 wave_ror:1 row_mask:0x1 bank_mask:0x1
ds_read_b64_tr_b16 v[52:53], v106 offset:2048
v_mfma_f32_16x16x32_bf16 v[120:123], v[82:85], v[30:33], v[120:123]
v_add_f32_dpp v94, v15, v91 wave_shr:1 row_mask:0xf bank_mask:0xf
ds_read_b64_tr_b16 v[54:55], v106 offset:2176
v_mfma_f32_16x16x32_bf16 v[120:123], v[78:81], v[36:39], v[120:123]
v_add_f32_dpp v8, v94, v90 wave_shr:1 row_mask:0xf bank_mask:0xf
v_add_f32_dpp v9, v93, v118 wave_ror:1 row_mask:0x1 bank_mask:0x1
v_mfma_f32_16x16x32_bf16 v[120:123], v[74:77], v[40:43], v[120:123]
v_add_f32_dpp v10, v15, v117 wave_ror:1 row_mask:0x1 bank_mask:0x1
v_add_f32_dpp v9, v119, v118 wave_shr:1 row_mask:0xf bank_mask:0xf
v_mfma_f32_16x16x32_bf16 v[120:123], v[70:73], v[44:47], v[120:123]
v_add_f32_dpp v14, v94, v116 wave_ror:1 row_mask:0x1 bank_mask:0x1
v_add_f32_dpp v10, v9, v117 wave_shr:1 row_mask:0xf bank_mask:0xf
v_mfma_f32_16x16x32_bf16 v[128:131], v[86:89], v[16:19], 0
s_waitcnt lgkmcnt(0)
buffer_store_dwordx4 v[124:127], v108, s[24:27], s48 offen
v_add_f32_dpp v14, v10, v116 wave_shr:1 row_mask:0xf bank_mask:0xf
v_cvt_pk_bf16_f32 v11, v13, v8
ds_write_addtid_b32 v11 offset:5632
v_mfma_f32_16x16x32_bf16 v[128:131], v[4:7], v[20:23], v[128:131]
v_mfma_f32_16x16x32_bf16 v[128:131], v[100:103], v[24:27], v[128:131]
v_add_f32_dpp v12, v119, v122 wave_ror:1 row_mask:0x1 bank_mask:0x1
s_setprio 2
v_add_f32_dpp v15, v9, v121 wave_ror:1 row_mask:0x1 bank_mask:0x1
v_mfma_f32_16x16x32_bf16 v[128:131], v[96:99], v[28:31], v[128:131]
v_add_f32_dpp v12, v123, v122 wave_shr:1 row_mask:0xf bank_mask:0xf
v_add_f32_dpp v90, v10, v120 wave_ror:1 row_mask:0x1 bank_mask:0x1
ds_read_b64_tr_b16 v[56:57], v106 offset:2304
v_mfma_f32_16x16x32_bf16 v[128:131], v[82:85], v[34:37], v[128:131]
v_add_f32_dpp v15, v12, v121 wave_shr:1 row_mask:0xf bank_mask:0xf
ds_read_b64_tr_b16 v[8:9], v105 offset:2432
ds_read_b64_tr_b16 v[10:11], v105 offset:2304
v_mfma_f32_16x16x32_bf16 v[128:131], v[78:81], v[38:41], v[128:131]
v_add_f32_dpp v90, v15, v120 wave_shr:1 row_mask:0xf bank_mask:0xf
v_cvt_pk_bf16_f32 v13, v14, v90
ds_write_addtid_b32 v13 offset:5888
v_mfma_f32_16x16x32_bf16 v[128:131], v[74:77], v[42:45], v[128:131]
v_mfma_f32_16x16x32_bf16 v[128:131], v[70:73], v[46:49], v[128:131]
v_mfma_f32_16x16x32_bf16 v[92:95], v[86:89], v[18:21], 0
v_mfma_f32_16x16x32_bf16 v[92:95], v[4:7], v[22:25], v[92:95]
v_mfma_f32_16x16x32_bf16 v[92:95], v[100:103], v[26:29], v[92:95]
s_nop 4
v_add_f32_dpp v91, v123, v130 wave_ror:1 row_mask:0x1 bank_mask:0x1
v_add_f32_dpp v104, v12, v129 wave_ror:1 row_mask:0x1 bank_mask:0x1
v_mfma_f32_16x16x32_bf16 v[92:95], v[96:99], v[30:33], v[92:95]
v_add_f32_dpp v91, v131, v130 wave_shr:1 row_mask:0xf bank_mask:0xf
v_add_f32_dpp v107, v15, v128 wave_ror:1 row_mask:0x1 bank_mask:0x1
v_mfma_f32_16x16x32_bf16 v[92:95], v[82:85], v[36:39], v[92:95]
s_setprio 1
v_add_f32_dpp v104, v91, v129 wave_shr:1 row_mask:0xf bank_mask:0xf
v_mfma_f32_16x16x32_bf16 v[92:95], v[78:81], v[40:43], v[92:95]
s_nop 0
v_add_f32_dpp v107, v104, v128 wave_shr:1 row_mask:0xf bank_mask:0xf
ds_read_b64_tr_b16 v[58:59], v106 offset:2432
v_mfma_f32_16x16x32_bf16 v[92:95], v[74:77], v[44:47], v[92:95]
v_mfma_f32_16x16x32_bf16 v[92:95], v[70:73], v[48:51], v[92:95]
v_mfma_f32_16x16x32_bf16 v[116:119], v[0:3], v[16:19], 0
v_mfma_f32_16x16x32_bf16 v[116:119], v[86:89], v[20:23], v[116:119]
v_mfma_f32_16x16x32_bf16 v[116:119], v[4:7], v[24:27], v[116:119]
s_nop 4
v_add_f32_dpp v90, v131, v94 wave_ror:1 row_mask:0x1 bank_mask:0x1
v_add_f32_dpp v111, v91, v93 wave_ror:1 row_mask:0x1 bank_mask:0x1
v_mfma_f32_16x16x32_bf16 v[116:119], v[100:103], v[28:31], v[116:119]
v_add_f32_dpp v90, v95, v94 wave_shr:1 row_mask:0xf bank_mask:0xf
v_add_f32_dpp v12, v104, v92 wave_ror:1 row_mask:0x1 bank_mask:0x1
v_mfma_f32_16x16x32_bf16 v[116:119], v[96:99], v[34:37], v[116:119]
v_add_f32_dpp v111, v90, v93 wave_shr:1 row_mask:0xf bank_mask:0xf
v_mfma_f32_16x16x32_bf16 v[116:119], v[82:85], v[38:41], v[116:119]
s_nop 0
v_add_f32_dpp v12, v111, v92 wave_shr:1 row_mask:0xf bank_mask:0xf
v_cvt_pk_bf16_f32 v13, v107, v12
ds_write_addtid_b32 v13 offset:6144
ds_write_b32 v113, v114 offset:32
v_mfma_f32_16x16x32_bf16 v[116:119], v[78:81], v[42:45], v[116:119]
s_setprio 0
v_mfma_f32_16x16x32_bf16 v[116:119], v[74:77], v[46:49], v[116:119]
ds_read_b64_tr_b16 v[60:61], v106 offset:2560
v_mfma_f32_16x16x32_bf16 v[116:119], v[70:73], v[52:55], v[116:119]
ds_read_b64_tr_b16 v[12:13], v105 offset:2688
ds_read_b64_tr_b16 v[14:15], v105 offset:2560
v_mfma_f32_16x16x32_bf16 v[120:123], v[0:3], v[18:21], 0
v_mfma_f32_16x16x32_bf16 v[120:123], v[86:89], v[22:25], v[120:123]
ds_read_b32 v91, v112 offset:32
v_mfma_f32_16x16x32_bf16 v[120:123], v[4:7], v[26:29], v[120:123]
s_nop 1
v_add_f32_dpp v104, v95, v118 wave_ror:1 row_mask:0x1 bank_mask:0x1
v_add_f32_dpp v107, v90, v117 wave_ror:1 row_mask:0x1 bank_mask:0x1
v_mfma_f32_16x16x32_bf16 v[120:123], v[100:103], v[30:33], v[120:123]
v_add_f32_dpp v104, v119, v118 wave_shr:1 row_mask:0xf bank_mask:0xf
v_add_f32_dpp v115, v111, v116 wave_ror:1 row_mask:0x1 bank_mask:0x1
v_mfma_f32_16x16x32_bf16 v[120:123], v[96:99], v[36:39], v[120:123]
v_add_f32_dpp v107, v104, v117 wave_shr:1 row_mask:0xf bank_mask:0xf
v_mfma_f32_16x16x32_bf16 v[120:123], v[82:85], v[40:43], v[120:123]
s_nop 0
v_add_f32_dpp v115, v107, v116 wave_shr:1 row_mask:0xf bank_mask:0xf
v_mfma_f32_16x16x32_bf16 v[120:123], v[78:81], v[44:47], v[120:123]
v_mfma_f32_16x16x32_bf16 v[120:123], v[74:77], v[48:51], v[120:123]
s_waitcnt lgkmcnt(0)
v_cmp_ne_u32 vcc, 1, v91
s_cbranch_vccnz L_f10r
L_f10:
s_setprio 3
ds_read_b64_tr_b16 v[92:93], v109 offset:1024
ds_read_b64_tr_b16 v[94:95], v109 offset:36096
v_mfma_f32_16x16x32_bf16 v[120:123], v[70:73], v[54:57], v[120:123]
s_add_u32 s48, s54, 0x120000
v_mfma_f32_16x16x32_bf16 v[124:127], v[8:11], v[16:19], 0
ds_read_b64_tr_b16 v[62:63], v106 offset:2688
v_mfma_f32_16x16x32_bf16 v[124:127], v[0:3], v[20:23], v[124:127]
v_mfma_f32_16x16x32_bf16 v[124:127], v[86:89], v[24:27], v[124:127]
s_nop 2
v_add_f32_dpp v90, v119, v122 wave_ror:1 row_mask:0x1 bank_mask:0x1
v_add_f32_dpp v111, v104, v121 wave_ror:1 row_mask:0x1 bank_mask:0x1
v_mfma_f32_16x16x32_bf16 v[124:127], v[4:7], v[28:31], v[124:127]
v_add_f32_dpp v90, v123, v122 wave_shr:1 row_mask:0xf bank_mask:0xf
v_add_f32_dpp v91, v107, v120 wave_ror:1 row_mask:0x1 bank_mask:0x1
v_mfma_f32_16x16x32_bf16 v[124:127], v[100:103], v[34:37], v[124:127]
s_waitcnt lgkmcnt(0)
buffer_store_dwordx4 v[92:95], v108, s[24:27], s48 offen
v_add_f32_dpp v111, v90, v121 wave_shr:1 row_mask:0xf bank_mask:0xf
v_mfma_f32_16x16x32_bf16 v[124:127], v[96:99], v[38:41], v[124:127]
s_nop 0
v_add_f32_dpp v91, v111, v120 wave_shr:1 row_mask:0xf bank_mask:0xf
v_cvt_pk_bf16_f32 v109, v115, v91
ds_write_addtid_b32 v109 offset:6400
v_mfma_f32_16x16x32_bf16 v[124:127], v[82:85], v[42:45], v[124:127]
v_mfma_f32_16x16x32_bf16 v[124:127], v[78:81], v[46:49], v[124:127]
s_setprio 2
v_mfma_f32_16x16x32_bf16 v[124:127], v[74:77], v[52:55], v[124:127]
v_mfma_f32_16x16x32_bf16 v[124:127], v[70:73], v[56:59], v[124:127]
v_mfma_f32_16x16x32_bf16 v[116:119], v[8:11], v[18:21], 0
v_mfma_f32_16x16x32_bf16 v[116:119], v[0:3], v[22:25], v[116:119]
ds_read_b64_tr_b16 v[64:65], v106 offset:2816
v_mfma_f32_16x16x32_bf16 v[116:119], v[86:89], v[26:29], v[116:119]
s_nop 3
v_add_f32_dpp v92, v123, v126 wave_ror:1 row_mask:0x1 bank_mask:0x1
v_add_f32_dpp v93, v90, v125 wave_ror:1 row_mask:0x1 bank_mask:0x1
ds_read_b64_tr_b16 v[128:129], v105 offset:2944
ds_read_b64_tr_b16 v[130:131], v105 offset:2816
v_mfma_f32_16x16x32_bf16 v[116:119], v[4:7], v[30:33], v[116:119]
v_add_f32_dpp v92, v127, v126 wave_shr:1 row_mask:0xf bank_mask:0xf
v_add_f32_dpp v91, v111, v124 wave_ror:1 row_mask:0x1 bank_mask:0x1
v_mfma_f32_16x16x32_bf16 v[116:119], v[100:103], v[36:39], v[116:119]
v_add_f32_dpp v93, v92, v125 wave_shr:1 row_mask:0xf bank_mask:0xf
v_mfma_f32_16x16x32_bf16 v[116:119], v[96:99], v[40:43], v[116:119]
s_nop 0
v_add_f32_dpp v91, v93, v124 wave_shr:1 row_mask:0xf bank_mask:0xf
v_mfma_f32_16x16x32_bf16 v[116:119], v[82:85], v[44:47], v[116:119]
v_mfma_f32_16x16x32_bf16 v[116:119], v[78:81], v[48:51], v[116:119]
s_setprio 1
v_mfma_f32_16x16x32_bf16 v[116:119], v[74:77], v[54:57], v[116:119]
v_mfma_f32_16x16x32_bf16 v[116:119], v[70:73], v[58:61], v[116:119]
v_mfma_f32_16x16x32_bf16 v[120:123], v[12:15], v[16:19], 0
v_mfma_f32_16x16x32_bf16 v[120:123], v[8:11], v[20:23], v[120:123]
v_mfma_f32_16x16x32_bf16 v[120:123], v[0:3], v[24:27], v[120:123]
s_nop 4
v_add_f32_dpp v90, v127, v118 wave_ror:1 row_mask:0x1 bank_mask:0x1
v_add_f32_dpp v94, v92, v117 wave_ror:1 row_mask:0x1 bank_mask:0x1
v_mfma_f32_16x16x32_bf16 v[120:123], v[86:89], v[28:31], v[120:123]
v_add_f32_dpp v90, v119, v118 wave_shr:1 row_mask:0xf bank_mask:0xf
v_add_f32_dpp v95, v93, v116 wave_ror:1 row_mask:0x1 bank_mask:0x1
ds_read_b64_tr_b16 v[66:67], v106 offset:2944
v_mfma_f32_16x16x32_bf16 v[120:123], v[4:7], v[34:37], v[120:123]
v_add_f32_dpp v94, v90, v117 wave_shr:1 row_mask:0xf bank_mask:0xf
v_mfma_f32_16x16x32_bf16 v[120:123], v[100:103], v[38:41], v[120:123]
s_nop 0
v_add_f32_dpp v95, v94, v116 wave_shr:1 row_mask:0xf bank_mask:0xf
v_cvt_pk_bf16_f32 v104, v91, v95
ds_write_addtid_b32 v104 offset:6656
ds_write_b32 v113, v114 offset:64
v_mfma_f32_16x16x32_bf16 v[120:123], v[96:99], v[42:45], v[120:123]
s_setprio 0
v_mfma_f32_16x16x32_bf16 v[120:123], v[82:85], v[46:49], v[120:123]
v_mfma_f32_16x16x32_bf16 v[120:123], v[78:81], v[52:55], v[120:123]
v_mfma_f32_16x16x32_bf16 v[120:123], v[74:77], v[56:59], v[120:123]
v_mfma_f32_16x16x32_bf16 v[120:123], v[70:73], v[60:63], v[120:123]
ds_read_b32 v92, v112 offset:64
v_mfma_f32_16x16x32_bf16 v[124:127], v[12:15], v[18:21], 0
v_mfma_f32_16x16x32_bf16 v[124:127], v[8:11], v[22:25], v[124:127]
v_mfma_f32_16x16x32_bf16 v[124:127], v[0:3], v[26:29], v[124:127]
s_nop 3
v_add_f32_dpp v91, v119, v122 wave_ror:1 row_mask:0x1 bank_mask:0x1
v_add_f32_dpp v93, v90, v121 wave_ror:1 row_mask:0x1 bank_mask:0x1
v_mfma_f32_16x16x32_bf16 v[124:127], v[86:89], v[30:33], v[124:127]
v_add_f32_dpp v91, v123, v122 wave_shr:1 row_mask:0xf bank_mask:0xf
v_add_f32_dpp v95, v94, v120 wave_ror:1 row_mask:0x1 bank_mask:0x1
v_mfma_f32_16x16x32_bf16 v[124:127], v[4:7], v[36:39], v[124:127]
v_add_f32_dpp v93, v91, v121 wave_shr:1 row_mask:0xf bank_mask:0xf
v_mfma_f32_16x16x32_bf16 v[124:127], v[100:103], v[40:43], v[124:127]
s_waitcnt lgkmcnt(0)
v_cmp_ne_u32 vcc, 1, v92
s_cbranch_vccnz L_f11r
L_f11:
v_add_f32_dpp v95, v93, v120 wave_shr:1 row_mask:0xf bank_mask:0xf
ds_read_b64_tr_b16 v[104:105], v110 offset:2048
v_mfma_f32_16x16x32_bf16 v[124:127], v[96:99], v[44:47], v[124:127]
ds_read_b64_tr_b16 v[106:107], v110 offset:37120
s_add_u32 s48, s55, 0x240000
v_mfma_f32_16x16x32_bf16 v[124:127], v[82:85], v[48:51], v[124:127]
v_mfma_f32_16x16x32_bf16 v[124:127], v[78:81], v[54:57], v[124:127]
v_mfma_f32_16x16x32_bf16 v[124:127], v[74:77], v[58:61], v[124:127]
v_mfma_f32_16x16x32_bf16 v[124:127], v[70:73], v[62:65], v[124:127]
v_mfma_f32_16x16x32_bf16 v[114:117], v[128:131], v[16:19], 0
v_mfma_f32_16x16x32_bf16 v[114:117], v[12:15], v[20:23], v[114:117]
s_mov_b32 exec_hi, 0
s_waitcnt lgkmcnt(0)
buffer_store_dwordx4 v[104:107], v108, s[24:27], s48 offen
s_mov_b64 exec, -1
v_mfma_f32_16x16x32_bf16 v[114:117], v[8:11], v[24:27], v[114:117]
s_nop 0
v_add_f32_dpp v90, v123, v126 wave_ror:1 row_mask:0x1 bank_mask:0x1
v_add_f32_dpp v92, v91, v125 wave_ror:1 row_mask:0x1 bank_mask:0x1
v_mfma_f32_16x16x32_bf16 v[114:117], v[0:3], v[28:31], v[114:117]
v_add_f32_dpp v90, v127, v126 wave_shr:1 row_mask:0xf bank_mask:0xf
v_add_f32_dpp v94, v93, v124 wave_ror:1 row_mask:0x1 bank_mask:0x1
v_mfma_f32_16x16x32_bf16 v[114:117], v[86:89], v[34:37], v[114:117]
v_add_f32_dpp v92, v90, v125 wave_shr:1 row_mask:0xf bank_mask:0xf
v_mfma_f32_16x16x32_bf16 v[114:117], v[4:7], v[38:41], v[114:117]
s_nop 0
v_add_f32_dpp v94, v92, v124 wave_shr:1 row_mask:0xf bank_mask:0xf
v_cvt_pk_bf16_f32 v12, v95, v94
ds_write_addtid_b32 v12 offset:6912
v_mfma_f32_16x16x32_bf16 v[114:117], v[100:103], v[42:45], v[114:117]
v_mfma_f32_16x16x32_bf16 v[114:117], v[96:99], v[46:49], v[114:117]
v_mfma_f32_16x16x32_bf16 v[114:117], v[82:85], v[52:55], v[114:117]
v_mfma_f32_16x16x32_bf16 v[114:117], v[78:81], v[56:59], v[114:117]
v_mfma_f32_16x16x32_bf16 v[114:117], v[74:77], v[60:63], v[114:117]
v_mfma_f32_16x16x32_bf16 v[114:117], v[70:73], v[64:67], v[114:117]
s_nop 7
v_add_f32_dpp v0, v127, v116 wave_ror:1 row_mask:0x1 bank_mask:0x1
v_add_f32_dpp v1, v90, v115 wave_ror:1 row_mask:0x1 bank_mask:0x1
v_add_f32_dpp v0, v117, v116 wave_shr:1 row_mask:0xf bank_mask:0xf
v_add_f32_dpp v2, v92, v114 wave_ror:1 row_mask:0x1 bank_mask:0x1
s_nop 0
v_add_f32_dpp v1, v0, v115 wave_shr:1 row_mask:0xf bank_mask:0xf
s_nop 1
v_add_f32_dpp v2, v1, v114 wave_shr:1 row_mask:0xf bank_mask:0xf
v_cvt_pk_bf16_f32 v3, v2, v2
ds_write_addtid_b32 v3 offset:7168
s_add_u32 s48, s55, 0x2d0000
s_waitcnt lgkmcnt(0)
s_barrier
ds_read_b64_tr_b16 v[4:5], v110 offset:2560
ds_read_b64_tr_b16 v[6:7], v110 offset:37632
s_sub_u32 s47, s3, 4
s_mov_b32 exec_hi, 0
s_mov_b32 exec_lo, 0xffffffff
s_cmp_lt_u32 s47, 4
s_cselect_b32 exec_lo, 0x55555555, exec_lo
s_waitcnt lgkmcnt(0)
buffer_store_dwordx4 v[4:7], v108, s[24:27], s48 offen
s_mov_b64 exec, -1
s_endpgm
L_Ahi:
s_waitcnt lgkmcnt(7)
v_mfma_f32_32x32x16_bf16 v[0:15], v[76:79], v[16:19], v[0:15]
s_waitcnt lgkmcnt(6)
v_mfma_f32_32x32x16_bf16 v[0:15], v[80:83], v[20:23], v[0:15]
s_waitcnt lgkmcnt(5)
v_mfma_f32_32x32x16_bf16 v[0:15], v[60:63], v[24:27], v[0:15]
s_waitcnt lgkmcnt(4)
v_mfma_f32_32x32x16_bf16 v[0:15], v[72:75], v[28:31], v[0:15]
s_cmp_lt_u32 s3, 4
s_cbranch_scc0 L_u01
s_waitcnt vmcnt(0)
v_perm_b32 v68, v56, v52, s50
v_perm_b32 v69, v92, v88, s50
ds_write_b64 v107, v[68:69]
v_perm_b32 v160, v56, v52, s51
v_perm_b32 v161, v92, v88, s51
ds_write_b64 v107, v[160:161] offset:4256
v_perm_b32 v162, v57, v53, s50
v_perm_b32 v163, v93, v89, s50
ds_write_b64 v107, v[162:163] offset:8512
v_perm_b32 v78, v57, v53, s51
v_perm_b32 v79, v93, v89, s51
ds_write_b64 v107, v[78:79] offset:12768
v_perm_b32 v80, v58, v54, s50
v_perm_b32 v81, v94, v90, s50
ds_write_b64 v107, v[80:81] offset:17024
v_perm_b32 v82, v58, v54, s51
v_perm_b32 v83, v94, v90, s51
ds_write_b64 v107, v[82:83] offset:21280
v_perm_b32 v164, v59, v55, s50
v_perm_b32 v165, v95, v91, s50
ds_write_b64 v107, v[164:165] offset:25536
v_perm_b32 v166, v59, v55, s51
v_perm_b32 v167, v95, v91, s51
ds_write_b64 v107, v[166:167] offset:29792
v_mov_b32 v104, v104
L_u01:
s_waitcnt lgkmcnt(0)
v_mfma_f32_32x32x16_bf16 v[0:15], v[84:87], v[32:35], v[0:15]
v_mfma_f32_32x32x16_bf16 v[0:15], v[64:67], v[36:39], v[0:15]
v_mfma_f32_32x32x16_bf16 v[0:15], v[118:121], v[40:43], v[0:15]
v_mfma_f32_32x32x16_bf16 v[0:15], v[48:51], v[44:47], v[0:15]
s_nop 11
v_add_f32 v16, v0, v116
v_cvt_pk_bf16_f32 v145, v2, v3
v_cvt_pk_bf16_f32 v144, v16, v1
v_cvt_pk_bf16_f32 v148, v4, v5
v_cvt_pk_bf16_f32 v149, v6, v7
s_waitcnt lgkmcnt(0)
s_barrier
s_setprio 3
s_mov_b32 m0, s38
v_cvt_pk_bf16_f32 v18, v8, v8
v_cvt_pk_bf16_f32 v19, v8, v9
v_cvt_pk_bf16_f32 v20, v9, v9
v_cvt_pk_bf16_f32 v21, v10, v10
ds_write_b128 v102, v[18:21] offset:1024
v_cvt_pk_bf16_f32 v22, v12, v12
v_cvt_pk_bf16_f32 v25, v13, v13
v_cvt_pk_bf16_f32 v23, v12, v12
v_perm_b32 v24, v25, v22, v111
ds_write_b128 v103, v[22:25] offset:2048
v_cvt_pk_bf16_f32 v26, v14, v14
v_cvt_pk_bf16_f32 v29, v15, v15
v_cvt_pk_bf16_f32 v27, v14, v14
v_perm_b32 v28, v29, v26, v111
ds_write_b128 v103, v[26:29] offset:2560
ds_read_b64_tr_b16 v[116:117], v105 offset:2944
ds_read_b64_tr_b16 v[118:119], v105 offset:2816
ds_read_b64_tr_b16 v[16:17], v106
ds_read_b64_tr_b16 v[18:19], v106 offset:128
ds_read_b64_tr_b16 v[20:21], v106 offset:256
ds_read_b64_tr_b16 v[70:71], v105 offset:3200
ds_read_b64_tr_b16 v[72:73], v105 offset:3072
ds_read_b64_tr_b16 v[74:75], v105 offset:3456
ds_read_b64_tr_b16 v[76:77], v105 offset:3328
ds_read_b64_tr_b16 v[60:61], v105 offset:3712
ds_read_b64_tr_b16 v[62:63], v105 offset:3584
ds_read_b64_tr_b16 v[34:35], v105 offset:3968
ds_read_b64_tr_b16 v[36:37], v105 offset:3840
s_waitcnt lgkmcnt(9)
v_mfma_f32_16x16x32_bf16 v[0:3], v[116:119], v[16:19], 0
ds_read_b64_tr_b16 v[4:5], v105 offset:2688
ds_read_b64_tr_b16 v[6:7], v105 offset:2560
s_waitcnt lgkmcnt(10)
v_mfma_f32_16x16x32_bf16 v[8:11], v[116:119], v[18:21], 0
ds_read_b64_tr_b16 v[22:23], v106 offset:384
ds_read_b64_tr_b16 v[24:25], v106 offset:512
s_waitcnt lgkmcnt(10)
v_mfma_f32_16x16x32_bf16 v[12:15], v[70:73], v[16:19], 0
ds_read_b64_tr_b16 v[120:121], v105 offset:2432
ds_read_b64_tr_b16 v[122:123], v105 offset:2304
v_mfma_f32_16x16x32_bf16 v[124:127], v[70:73], v[18:21], 0
s_setprio 2
ds_read_b64_tr_b16 v[26:27], v106 offset:640
ds_read_b64_tr_b16 v[28:29], v106 offset:768
s_waitcnt lgkmcnt(8)
v_mfma_f32_16x16x32_bf16 v[128:131], v[74:77], v[16:19], 0
ds_read_b64_tr_b16 v[132:133], v105 offset:2176
ds_read_b64_tr_b16 v[134:135], v105 offset:2048
v_mfma_f32_16x16x32_bf16 v[136:139], v[74:77], v[18:21], 0
ds_read_b64_tr_b16 v[30:31], v106 offset:896
ds_read_b64_tr_b16 v[32:33], v106 offset:1024
v_mfma_f32_16x16x32_bf16 v[140:143], v[60:63], v[16:19], 0
ds_write_b64 v101, v[144:145]
s_mov_b64 exec, 0xffffff
ds_write_b32 v97, v115
s_mov_b64 exec, -1
v_mfma_f32_16x16x32_bf16 v[144:147], v[60:63], v[18:21], 0
ds_write_b64 v101, v[148:149] offset:512
v_mfma_f32_16x16x32_bf16 v[148:151], v[34:37], v[16:19], 0
v_mfma_f32_16x16x32_bf16 v[152:155], v[34:37], v[18:21], 0
s_waitcnt lgkmcnt(3)
v_mfma_f32_16x16x32_bf16 v[0:3], v[4:7], v[20:23], v[0:3]
ds_read_b64_tr_b16 v[156:157], v105 offset:1920
ds_read_b64_tr_b16 v[158:159], v105 offset:1792
v_mfma_f32_16x16x32_bf16 v[8:11], v[4:7], v[22:25], v[8:11]
ds_read_b64_tr_b16 v[34:35], v106 offset:1024
ds_read_b64_tr_b16 v[36:37], v106 offset:1152
v_mfma_f32_16x16x32_bf16 v[12:15], v[116:119], v[20:23], v[12:15]
ds_read_b64_tr_b16 v[38:39], v106 offset:1280
v_mfma_f32_16x16x32_bf16 v[124:127], v[116:119], v[22:25], v[124:127]
v_mfma_f32_16x16x32_bf16 v[128:131], v[70:73], v[20:23], v[128:131]
ds_read_b64_tr_b16 v[100:101], v105 offset:1664
ds_read_b64_tr_b16 v[102:103], v105 offset:1536
s_setprio 1
v_mfma_f32_16x16x32_bf16 v[136:139], v[70:73], v[22:25], v[136:139]
ds_read_b64_tr_b16 v[40:41], v106 offset:1408
ds_read_b64_tr_b16 v[42:43], v106 offset:1536
v_mfma_f32_16x16x32_bf16 v[140:143], v[74:77], v[20:23], v[140:143]
v_mfma_f32_16x16x32_bf16 v[144:147], v[74:77], v[22:25], v[144:147]
v_mfma_f32_16x16x32_bf16 v[148:151], v[60:63], v[20:23], v[148:151]
s_cmp_lt_u32 s3, 4
s_cbranch_scc1 L_u11
s_waitcnt vmcnt(0)
v_perm_b32 v68, v56, v52, s50
v_perm_b32 v69, v92, v88, s50
ds_write_b64 v107, v[68:69]
v_perm_b32 v160, v56, v52, s51
v_perm_b32 v161, v92, v88, s51
ds_write_b64 v107, v[160:161] offset:4256
v_perm_b32 v162, v57, v53, s50
v_perm_b32 v163, v93, v89, s50
ds_write_b64 v107, v[162:163] offset:8512
v_perm_b32 v78, v57, v53, s51
v_perm_b32 v79, v93, v89, s51
ds_write_b64 v107, v[78:79] offset:12768
v_perm_b32 v80, v58, v54, s50
v_perm_b32 v81, v94, v90, s50
ds_write_b64 v107, v[80:81] offset:17024
v_perm_b32 v82, v58, v54, s51
v_perm_b32 v83, v94, v90, s51
ds_write_b64 v107, v[82:83] offset:21280
v_perm_b32 v164, v59, v55, s50
v_perm_b32 v165, v95, v91, s50
ds_write_b64 v107, v[164:165] offset:25536
v_perm_b32 v166, v59, v55, s51
v_perm_b32 v167, v95, v91, s51
ds_write_b64 v107, v[166:167] offset:29792
v_mov_b32 v104, v104
L_u11:
s_setprio 0
ds_write_b32 v113, v114 offset:224
v_mfma_f32_16x16x32_bf16 v[152:155], v[60:63], v[22:25], v[152:155]
ds_read_b64_tr_b16 v[160:161], v105 offset:1408
ds_read_b64_tr_b16 v[162:163], v105 offset:1280
v_mfma_f32_16x16x32_bf16 v[0:3], v[120:123], v[24:27], v[0:3]
ds_read_b64_tr_b16 v[44:45], v106 offset:1664
ds_read_b64_tr_b16 v[46:47], v106 offset:1792
v_mfma_f32_16x16x32_bf16 v[8:11], v[120:123], v[26:29], v[8:11]
v_mfma_f32_16x16x32_bf16 v[12:15], v[4:7], v[24:27], v[12:15]
ds_read_b64_tr_b16 v[88:89], v105 offset:1152
ds_read_b64_tr_b16 v[90:91], v105 offset:1024
v_mfma_f32_16x16x32_bf16 v[124:127], v[4:7], v[26:29], v[124:127]
ds_read_b32 v78, v112 offset:224
ds_read_b64_tr_b16 v[48:49], v106 offset:1920
v_mfma_f32_16x16x32_bf16 v[128:131], v[116:119], v[24:27], v[128:131]
ds_read_b64_tr_b16 v[50:51], v106 offset:2048
v_mfma_f32_16x16x32_bf16 v[136:139], v[116:119], v[26:29], v[136:139]
v_mfma_f32_16x16x32_bf16 v[140:143], v[70:73], v[24:27], v[140:143]
ds_read_b64_tr_b16 v[92:93], v105 offset:896
ds_read_b64_tr_b16 v[94:95], v105 offset:768
v_mfma_f32_16x16x32_bf16 v[144:147], v[70:73], v[26:29], v[144:147]
ds_read_b64_tr_b16 v[52:53], v106 offset:2048
v_mfma_f32_16x16x32_bf16 v[148:151], v[74:77], v[24:27], v[148:151]
ds_read_b64_tr_b16 v[164:165], v105 offset:640
ds_read_b64_tr_b16 v[166:167], v105 offset:512
v_mfma_f32_16x16x32_bf16 v[152:155], v[74:77], v[26:29], v[152:155]
s_waitcnt lgkmcnt(5)
v_cmp_ne_u32 vcc, 1, v78
s_cbranch_vccnz L_f12r
L_f12:
s_setprio 3
ds_read_b64_tr_b16 v[54:55], v106 offset:2176
ds_read_b64_tr_b16 v[56:57], v106 offset:2304
v_mfma_f32_16x16x32_bf16 v[0:3], v[132:135], v[28:31], v[0:3]
ds_read_b64_tr_b16 v[58:59], v106 offset:2432
ds_read_b64_tr_b16 v[60:61], v106 offset:2560
v_mfma_f32_16x16x32_bf16 v[8:11], v[132:135], v[30:33], v[8:11]
ds_read_b64_tr_b16 v[168:169], v105 offset:384
ds_read_b64_tr_b16 v[170:171], v105 offset:256
v_mfma_f32_16x16x32_bf16 v[12:15], v[120:123], v[28:31], v[12:15]
ds_read_b64_tr_b16 v[62:63], v106 offset:2688
ds_read_b64_tr_b16 v[64:65], v106 offset:2816
v_mfma_f32_16x16x32_bf16 v[124:127], v[120:123], v[30:33], v[124:127]
ds_read_b64_tr_b16 v[172:173], v105 offset:128
ds_read_b64_tr_b16 v[174:175], v105
v_mfma_f32_16x16x32_bf16 v[128:131], v[4:7], v[28:31], v[128:131]
ds_read_b64_tr_b16 v[66:67], v106 offset:2944
ds_read_b64_tr_b16 v[68:69], v106 offset:3072
v_mfma_f32_16x16x32_bf16 v[136:139], v[4:7], v[30:33], v[136:139]
v_mfma_f32_16x16x32_bf16 v[140:143], v[116:119], v[28:31], v[140:143]
v_mfma_f32_16x16x32_bf16 v[144:147], v[116:119], v[30:33], v[144:147]
v_mfma_f32_16x16x32_bf16 v[148:151], v[70:73], v[28:31], v[148:151]
v_mfma_f32_16x16x32_bf16 v[152:155], v[70:73], v[30:33], v[152:155]
v_mfma_f32_16x16x32_bf16 v[0:3], v[156:159], v[34:37], v[0:3]
v_mfma_f32_16x16x32_bf16 v[8:11], v[156:159], v[36:39], v[8:11]
v_mfma_f32_16x16x32_bf16 v[12:15], v[132:135], v[34:37], v[12:15]
ds_read_b64_tr_b16 v[70:71], v106 offset:3072
ds_read_b64_tr_b16 v[72:73], v106 offset:3200
v_mfma_f32_16x16x32_bf16 v[124:127], v[132:135], v[36:39], v[124:127]
ds_read_b64_tr_b16 v[74:75], v106 offset:3328
v_mfma_f32_16x16x32_bf16 v[0:3], v[100:103], v[38:41], v[0:3]
v_mfma_f32_16x16x32_bf16 v[8:11], v[100:103], v[40:43], v[8:11]
v_mfma_f32_16x16x32_bf16 v[12:15], v[156:159], v[38:41], v[12:15]
s_setprio 2
v_mfma_f32_16x16x32_bf16 v[124:127], v[156:159], v[40:43], v[124:127]
v_mfma_f32_16x16x32_bf16 v[0:3], v[160:163], v[42:45], v[0:3]
v_mfma_f32_16x16x32_bf16 v[8:11], v[160:163], v[44:47], v[8:11]
v_mfma_f32_16x16x32_bf16 v[12:15], v[100:103], v[42:45], v[12:15]
v_mfma_f32_16x16x32_bf16 v[124:127], v[100:103], v[44:47], v[124:127]
v_mfma_f32_16x16x32_bf16 v[0:3], v[88:91], v[46:49], v[0:3]
v_mfma_f32_16x16x32_bf16 v[8:11], v[88:91], v[48:51], v[8:11]
v_mfma_f32_16x16x32_bf16 v[12:15], v[160:163], v[46:49], v[12:15]
v_mfma_f32_16x16x32_bf16 v[124:127], v[160:163], v[48:51], v[124:127]
s_waitcnt lgkmcnt(0)
v_mfma_f32_16x16x32_bf16 v[0:3], v[92:95], v[52:55], v[0:3]
v_mfma_f32_16x16x32_bf16 v[8:11], v[92:95], v[54:57], v[8:11]
v_mfma_f32_16x16x32_bf16 v[0:3], v[164:167], v[56:59], v[0:3]
v_mfma_f32_16x16x32_bf16 v[8:11], v[164:167], v[58:61], v[8:11]
v_mfma_f32_16x16x32_bf16 v[0:3], v[168:171], v[60:63], v[0:3]
v_mfma_f32_16x16x32_bf16 v[8:11], v[168:171], v[62:65], v[8:11]
v_mfma_f32_16x16x32_bf16 v[0:3], v[172:175], v[64:67], v[0:3]
ds_read_b64_tr_b16 v[76:77], v106 offset:3456
v_mfma_f32_16x16x32_bf16 v[8:11], v[172:175], v[66:69], v[8:11]
ds_read_b64_tr_b16 v[78:79], v106 offset:3584
v_mfma_f32_16x16x32_bf16 v[12:15], v[88:91], v[52:55], v[12:15]
v_mfma_f32_16x16x32_bf16 v[124:127], v[88:91], v[54:57], v[124:127]
s_setprio 1
s_nop 1
v_add_f32_dpp v16, v3, v2 wave_shr:1 row_mask:0xf bank_mask:0xf bound_ctrl:0
v_mfma_f32_16x16x32_bf16 v[12:15], v[92:95], v[56:59], v[12:15]
s_nop 0
v_add_f32_dpp v17, v16, v1 wave_shr:1 row_mask:0xf bank_mask:0xf bound_ctrl:0
v_add_f32_dpp v18, v3, v10 wave_ror:1 row_mask:0x1 bank_mask:0x1
v_mfma_f32_16x16x32_bf16 v[124:127], v[92:95], v[58:61], v[124:127]
v_add_f32_dpp v19, v16, v9 wave_ror:1 row_mask:0x1 bank_mask:0x1
v_add_f32_dpp v18, v11, v10 wave_shr:1 row_mask:0xf bank_mask:0xf
v_mfma_f32_16x16x32_bf16 v[12:15], v[164:167], v[60:63], v[12:15]
v_add_f32_dpp v20, v17, v8 wave_ror:1 row_mask:0x1 bank_mask:0x1
v_add_f32_dpp v19, v18, v9 wave_shr:1 row_mask:0xf bank_mask:0xf
v_mfma_f32_16x16x32_bf16 v[124:127], v[164:167], v[62:65], v[124:127]
s_nop 0
v_add_f32_dpp v20, v19, v8 wave_shr:1 row_mask:0xf bank_mask:0xf
v_cvt_pk_bf16_f32 v21, v20, v20
ds_write_addtid_b32 v21 offset:7168
v_mfma_f32_16x16x32_bf16 v[12:15], v[168:171], v[64:67], v[12:15]
v_mfma_f32_16x16x32_bf16 v[124:127], v[168:171], v[66:69], v[124:127]
v_mfma_f32_16x16x32_bf16 v[12:15], v[172:175], v[70:73], v[12:15]
v_mfma_f32_16x16x32_bf16 v[124:127], v[172:175], v[72:75], v[124:127]
v_mfma_f32_16x16x32_bf16 v[128:131], v[120:123], v[34:37], v[128:131]
v_mfma_f32_16x16x32_bf16 v[136:139], v[120:123], v[36:39], v[136:139]
s_nop 4
v_add_f32_dpp v0, v11, v14 wave_ror:1 row_mask:0x1 bank_mask:0x1
v_add_f32_dpp v1, v18, v13 wave_ror:1 row_mask:0x1 bank_mask:0x1
v_mfma_f32_16x16x32_bf16 v[128:131], v[132:135], v[38:41], v[128:131]
v_add_f32_dpp v0, v15, v14 wave_shr:1 row_mask:0xf bank_mask:0xf
v_add_f32_dpp v2, v19, v12 wave_ror:1 row_mask:0x1 bank_mask:0x1
v_mfma_f32_16x16x32_bf16 v[136:139], v[132:135], v[40:43], v[136:139]
v_add_f32_dpp v1, v0, v13 wave_shr:1 row_mask:0xf bank_mask:0xf
v_mfma_f32_16x16x32_bf16 v[128:131], v[156:159], v[42:45], v[128:131]
s_setprio 0
v_add_f32_dpp v2, v1, v12 wave_shr:1 row_mask:0xf bank_mask:0xf
v_add_f32_dpp v3, v15, v126 wave_ror:1 row_mask:0x1 bank_mask:0x1
v_mfma_f32_16x16x32_bf16 v[136:139], v[156:159], v[44:47], v[136:139]
v_add_f32_dpp v16, v0, v125 wave_ror:1 row_mask:0x1 bank_mask:0x1
v_add_f32_dpp v3, v127, v126 wave_shr:1 row_mask:0xf bank_mask:0xf
v_mfma_f32_16x16x32_bf16 v[128:131], v[100:103], v[46:49], v[128:131]
v_add_f32_dpp v8, v1, v124 wave_ror:1 row_mask:0x1 bank_mask:0x1
v_add_f32_dpp v16, v3, v125 wave_shr:1 row_mask:0xf bank_mask:0xf
v_mfma_f32_16x16x32_bf16 v[136:139], v[100:103], v[48:51], v[136:139]
s_nop 0
v_add_f32_dpp v8, v16, v124 wave_shr:1 row_mask:0xf bank_mask:0xf
v_cvt_pk_bf16_f32 v9, v2, v8
ds_write_addtid_b32 v9 offset:7424
ds_write_b32 v113, v114
v_mfma_f32_16x16x32_bf16 v[128:131], v[160:163], v[52:55], v[128:131]
v_mfma_f32_16x16x32_bf16 v[136:139], v[160:163], v[54:57], v[136:139]
v_mfma_f32_16x16x32_bf16 v[128:131], v[88:91], v[56:59], v[128:131]
ds_read_b64_tr_b16 v[80:81], v106 offset:3712
v_mfma_f32_16x16x32_bf16 v[136:139], v[88:91], v[58:61], v[136:139]
ds_read_b64_tr_b16 v[82:83], v106 offset:3840
v_mfma_f32_16x16x32_bf16 v[128:131], v[92:95], v[60:63], v[128:131]
ds_read_b32 v0, v112
v_mfma_f32_16x16x32_bf16 v[136:139], v[92:95], v[62:65], v[136:139]
v_mfma_f32_16x16x32_bf16 v[128:131], v[164:167], v[64:67], v[128:131]
v_mfma_f32_16x16x32_bf16 v[136:139], v[164:167], v[66:69], v[136:139]
v_mfma_f32_16x16x32_bf16 v[128:131], v[168:171], v[70:73], v[128:131]
v_mfma_f32_16x16x32_bf16 v[136:139], v[168:171], v[72:75], v[136:139]
s_waitcnt lgkmcnt(0)
v_mfma_f32_16x16x32_bf16 v[128:131], v[172:175], v[74:77], v[128:131]
v_cmp_ne_u32 vcc, 1, v0
s_cbranch_vccnz L_f13r
L_f13:
s_setprio 3
ds_read_b64_tr_b16 v[8:9], v110 offset:2816
ds_read_b64_tr_b16 v[10:11], v110 offset:37888
v_mfma_f32_16x16x32_bf16 v[136:139], v[172:175], v[76:79], v[136:139]
s_add_u32 s48, s55, 0x318000
v_mfma_f32_16x16x32_bf16 v[140:143], v[4:7], v[34:37], v[140:143]
v_mfma_f32_16x16x32_bf16 v[144:147], v[4:7], v[36:39], v[144:147]
v_add_f32_dpp v1, v127, v130 wave_ror:1 row_mask:0x1 bank_mask:0x1
v_add_f32_dpp v2, v3, v129 wave_ror:1 row_mask:0x1 bank_mask:0x1
v_mfma_f32_16x16x32_bf16 v[140:143], v[120:123], v[38:41], v[140:143]
v_add_f32_dpp v1, v131, v130 wave_shr:1 row_mask:0xf bank_mask:0xf
v_add_f32_dpp v0, v16, v128 wave_ror:1 row_mask:0x1 bank_mask:0x1
v_mfma_f32_16x16x32_bf16 v[144:147], v[120:123], v[40:43], v[144:147]
s_setprio 2
v_add_f32_dpp v2, v1, v129 wave_shr:1 row_mask:0xf bank_mask:0xf
v_mfma_f32_16x16x32_bf16 v[140:143], v[132:135], v[42:45], v[140:143]
s_nop 0
v_add_f32_dpp v0, v2, v128 wave_shr:1 row_mask:0xf bank_mask:0xf
s_sub_u32 s47, s3, 0
s_mov_b32 exec_hi, 0
s_mov_b32 exec_lo, 0xffffffff
s_cmp_lt_u32 s47, 4
s_cselect_b32 exec_lo, 0xaaaaaaaa, exec_lo
s_waitcnt lgkmcnt(0)
buffer_store_dwordx4 v[8:11], v108, s[24:27], s48 offen
s_mov_b64 exec, -1
v_add_f32_dpp v3, v131, v138 wave_ror:1 row_mask:0x1 bank_mask:0x1
v_mfma_f32_16x16x32_bf16 v[144:147], v[132:135], v[44:47], v[144:147]
v_add_f32_dpp v12, v1, v137 wave_ror:1 row_mask:0x1 bank_mask:0x1
v_add_f32_dpp v3, v139, v138 wave_shr:1 row_mask:0xf bank_mask:0xf
v_mfma_f32_16x16x32_bf16 v[140:143], v[156:159], v[46:49], v[140:143]
v_add_f32_dpp v13, v2, v136 wave_ror:1 row_mask:0x1 bank_mask:0x1
s_setprio 1
v_add_f32_dpp v12, v3, v137 wave_shr:1 row_mask:0xf bank_mask:0xf
v_mfma_f32_16x16x32_bf16 v[144:147], v[156:159], v[48:51], v[144:147]
s_nop 0
v_add_f32_dpp v13, v12, v136 wave_shr:1 row_mask:0xf bank_mask:0xf
v_cvt_pk_bf16_f32 v14, v0, v13
ds_write_addtid_b32 v14 offset:7680
ds_write_b32 v113, v114 offset:32
v_mfma_f32_16x16x32_bf16 v[140:143], v[100:103], v[52:55], v[140:143]
v_mfma_f32_16x16x32_bf16 v[144:147], v[100:103], v[54:57], v[144:147]
v_mfma_f32_16x16x32_bf16 v[140:143], v[160:163], v[56:59], v[140:143]
v_mfma_f32_16x16x32_bf16 v[144:147], v[160:163], v[58:61], v[144:147]
v_mfma_f32_16x16x32_bf16 v[140:143], v[88:91], v[60:63], v[140:143]
s_setprio 0
ds_read_b32 v1, v112 offset:32
v_mfma_f32_16x16x32_bf16 v[144:147], v[88:91], v[62:65], v[144:147]
v_mfma_f32_16x16x32_bf16 v[140:143], v[92:95], v[64:67], v[140:143]
ds_read_b64_tr_b16 v[84:85], v106 offset:3968
v_mfma_f32_16x16x32_bf16 v[144:147], v[92:95], v[66:69], v[144:147]
ds_read_b64_tr_b16 v[86:87], v106 offset:4096
v_mfma_f32_16x16x32_bf16 v[140:143], v[164:167], v[70:73], v[140:143]
v_mfma_f32_16x16x32_bf16 v[144:147], v[164:167], v[72:75], v[144:147]
v_mfma_f32_16x16x32_bf16 v[140:143], v[168:171], v[74:77], v[140:143]
s_waitcnt lgkmcnt(1)
v_cmp_ne_u32 vcc, 1, v1
s_cbranch_vccnz L_f14r
L_f14:
s_setprio 3
ds_read_b64_tr_b16 v[8:9], v99 offset:3328
ds_read_b64_tr_b16 v[10:11], v99 offset:38400
v_mfma_f32_16x16x32_bf16 v[144:147], v[168:171], v[76:79], v[144:147]
s_add_u32 s48, s36, 0x3a8000
v_mfma_f32_16x16x32_bf16 v[140:143], v[172:175], v[78:81], v[140:143]
v_mfma_f32_16x16x32_bf16 v[144:147], v[172:175], v[80:83], v[144:147]
v_mfma_f32_16x16x32_bf16 v[148:151], v[116:119], v[34:37], v[148:151]
v_mfma_f32_16x16x32_bf16 v[152:155], v[116:119], v[36:39], v[152:155]
s_nop 4
v_add_f32_dpp v0, v139, v142 wave_ror:1 row_mask:0x1 bank_mask:0x1
v_add_f32_dpp v2, v3, v141 wave_ror:1 row_mask:0x1 bank_mask:0x1
v_mfma_f32_16x16x32_bf16 v[148:151], v[4:7], v[38:41], v[148:151]
s_mov_b64 exec, 0xffff
s_waitcnt lgkmcnt(0)
buffer_store_dwordx4 v[8:11], v108, s[24:27], s48 offen
s_mov_b64 exec, -1
v_add_f32_dpp v0, v143, v142 wave_shr:1 row_mask:0xf bank_mask:0xf
v_add_f32_dpp v1, v12, v140 wave_ror:1 row_mask:0x1 bank_mask:0x1
v_mfma_f32_16x16x32_bf16 v[152:155], v[4:7], v[40:43], v[152:155]
v_add_f32_dpp v2, v0, v141 wave_shr:1 row_mask:0xf bank_mask:0xf
s_setprio 2
v_mfma_f32_16x16x32_bf16 v[148:151], v[120:123], v[42:45], v[148:151]
v_add_f32_dpp v1, v2, v140 wave_shr:1 row_mask:0xf bank_mask:0xf
v_add_f32_dpp v13, v143, v146 wave_ror:1 row_mask:0x1 bank_mask:0x1
v_mfma_f32_16x16x32_bf16 v[152:155], v[120:123], v[44:47], v[152:155]
v_add_f32_dpp v3, v0, v145 wave_ror:1 row_mask:0x1 bank_mask:0x1
v_add_f32_dpp v13, v147, v146 wave_shr:1 row_mask:0xf bank_mask:0xf
v_mfma_f32_16x16x32_bf16 v[148:151], v[132:135], v[46:49], v[148:151]
v_add_f32_dpp v8, v2, v144 wave_ror:1 row_mask:0x1 bank_mask:0x1
v_add_f32_dpp v3, v13, v145 wave_shr:1 row_mask:0xf bank_mask:0xf
v_mfma_f32_16x16x32_bf16 v[152:155], v[132:135], v[48:51], v[152:155]
s_nop 0
v_add_f32_dpp v8, v3, v144 wave_shr:1 row_mask:0xf bank_mask:0xf
v_cvt_pk_bf16_f32 v4, v1, v8
ds_write_addtid_b32 v4 offset:7936
v_mfma_f32_16x16x32_bf16 v[148:151], v[156:159], v[52:55], v[148:151]
v_mfma_f32_16x16x32_bf16 v[152:155], v[156:159], v[54:57], v[152:155]
v_mfma_f32_16x16x32_bf16 v[148:151], v[100:103], v[56:59], v[148:151]
s_setprio 1
v_mfma_f32_16x16x32_bf16 v[152:155], v[100:103], v[58:61], v[152:155]
v_mfma_f32_16x16x32_bf16 v[148:151], v[160:163], v[60:63], v[148:151]
v_mfma_f32_16x16x32_bf16 v[152:155], v[160:163], v[62:65], v[152:155]
v_mfma_f32_16x16x32_bf16 v[148:151], v[88:91], v[64:67], v[148:151]
v_mfma_f32_16x16x32_bf16 v[152:155], v[88:91], v[66:69], v[152:155]
v_mfma_f32_16x16x32_bf16 v[148:151], v[92:95], v[70:73], v[148:151]
v_mfma_f32_16x16x32_bf16 v[152:155], v[92:95], v[72:75], v[152:155]
v_mfma_f32_16x16x32_bf16 v[148:151], v[164:167], v[74:77], v[148:151]
v_mfma_f32_16x16x32_bf16 v[152:155], v[164:167], v[76:79], v[152:155]
v_mfma_f32_16x16x32_bf16 v[148:151], v[168:171], v[78:81], v[148:151]
s_setprio 0
v_mfma_f32_16x16x32_bf16 v[152:155], v[168:171], v[80:83], v[152:155]
v_mfma_f32_16x16x32_bf16 v[148:151], v[172:175], v[82:85], v[148:151]
v_mfma_f32_16x16x32_bf16 v[152:155], v[172:175], v[84:87], v[152:155]
s_nop 6
v_add_f32_dpp v0, v147, v150 wave_ror:1 row_mask:0x1 bank_mask:0x1
v_add_f32_dpp v1, v13, v149 wave_ror:1 row_mask:0x1 bank_mask:0x1
v_add_f32_dpp v0, v151, v150 wave_shr:1 row_mask:0xf bank_mask:0xf
v_add_f32_dpp v2, v3, v148 wave_ror:1 row_mask:0x1 bank_mask:0x1
s_nop 0
v_add_f32_dpp v1, v0, v149 wave_shr:1 row_mask:0xf bank_mask:0xf
s_nop 1
v_add_f32_dpp v2, v1, v148 wave_shr:1 row_mask:0xf bank_mask:0xf
v_add_f32_dpp v4, v151, v154 wave_ror:1 row_mask:0x1 bank_mask:0x1
v_add_f32_dpp v5, v0, v153 wave_ror:1 row_mask:0x1 bank_mask:0x1
v_add_f32_dpp v4, v155, v154 wave_shr:1 row_mask:0xf bank_mask:0xf
v_add_f32_dpp v6, v1, v152 wave_ror:1 row_mask:0x1 bank_mask:0x1
s_nop 0
v_add_f32_dpp v5, v4, v153 wave_shr:1 row_mask:0xf bank_mask:0xf
s_nop 1
v_add_f32_dpp v6, v5, v152 wave_shr:1 row_mask:0xf bank_mask:0xf
v_cvt_pk_bf16_f32 v7, v2, v6
ds_write_addtid_b32 v7 offset:8192
s_add_u32 s48, s55, 0x3f0000
s_waitcnt lgkmcnt(0)
s_barrier
ds_read_b64_tr_b16 v[8:9], v110 offset:3584
ds_read_b64_tr_b16 v[10:11], v110 offset:38656
s_mov_b32 exec_hi, 0
s_waitcnt lgkmcnt(0)
buffer_store_dwordx4 v[8:11], v108, s[24:27], s48 offen
s_mov_b64 exec, -1
s_endpgm
L_end:
s_endpgm
L_f1r:
s_sleep 1
ds_read_b32 v35, v226
s_waitcnt lgkmcnt(0)
v_cmp_ne_u32 vcc, 1, v35
s_add_u32 s63, s63, 1
s_cmp_gt_u32 s63, 0x40000
s_cbranch_scc1 L_f1
s_nop 0
s_cbranch_vccnz L_f1r
s_branch L_f1
L_f2r:
s_sleep 1
ds_read_b32 v30, v226 offset:32
s_waitcnt lgkmcnt(0)
v_cmp_ne_u32 vcc, 1, v30
s_add_u32 s63, s63, 1
s_cmp_gt_u32 s63, 0x40000
s_cbranch_scc1 L_f2
s_nop 0
s_cbranch_vccnz L_f2r
s_branch L_f2
L_f3r:
s_sleep 1
ds_read_b32 v46, v226 offset:64
s_waitcnt lgkmcnt(0)
v_cmp_ne_u32 vcc, 1, v46
s_add_u32 s63, s63, 1
s_cmp_gt_u32 s63, 0x40000
s_cbranch_scc1 L_f3
s_nop 0
s_cbranch_vccnz L_f3r
s_branch L_f3
L_f4r:
s_sleep 1
ds_read_b32 v2, v226 offset:96
s_waitcnt lgkmcnt(0)
v_cmp_ne_u32 vcc, 1, v2
s_add_u32 s63, s63, 1
s_cmp_gt_u32 s63, 0x40000
s_cbranch_scc1 L_f4
s_nop 0
s_cbranch_vccnz L_f4r
s_branch L_f4
L_f5r:
s_sleep 1
ds_read_b32 v23, v226 offset:128
s_waitcnt lgkmcnt(0)
v_cmp_ne_u32 vcc, 1, v23
s_add_u32 s63, s63, 1
s_cmp_gt_u32 s63, 0x40000
s_cbranch_scc1 L_f5
s_nop 0
s_cbranch_vccnz L_f5r
s_branch L_f5
L_f6r:
s_sleep 1
ds_read_b32 v23, v226 offset:160
s_waitcnt lgkmcnt(0)
v_cmp_ne_u32 vcc, 1, v23
s_add_u32 s63, s63, 1
s_cmp_gt_u32 s63, 0x40000
s_cbranch_scc1 L_f6
s_nop 0
s_cbranch_vccnz L_f6r
s_branch L_f6
L_f7r:
s_sleep 1
ds_read_b32 v112, v226 offset:192
s_waitcnt lgkmcnt(0)
v_cmp_ne_u32 vcc, 1, v112
s_add_u32 s63, s63, 1
s_cmp_gt_u32 s63, 0x40000
s_cbranch_scc1 L_f7
s_nop 0
s_cbranch_vccnz L_f7r
s_branch L_f7
L_f8r:
s_sleep 1
ds_read_b32 v68, v112 offset:224
s_waitcnt lgkmcnt(0)
v_cmp_ne_u32 vcc, 1, v68
s_add_u32 s63, s63, 1
s_cmp_gt_u32 s63, 0x40000
s_cbranch_scc1 L_f8
s_nop 0
s_cbranch_vccnz L_f8r
s_branch L_f8
L_f9r:
s_sleep 1
ds_read_b32 v9, v112
s_waitcnt lgkmcnt(0)
v_cmp_ne_u32 vcc, 1, v9
s_add_u32 s63, s63, 1
s_cmp_gt_u32 s63, 0x40000
s_cbranch_scc1 L_f9
s_nop 0
s_cbranch_vccnz L_f9r
s_branch L_f9
L_f10r:
s_sleep 1
ds_read_b32 v91, v112 offset:32
s_waitcnt lgkmcnt(0)
v_cmp_ne_u32 vcc, 1, v91
s_add_u32 s63, s63, 1
s_cmp_gt_u32 s63, 0x40000
s_cbranch_scc1 L_f10
s_nop 0
s_cbranch_vccnz L_f10r
s_branch L_f10
L_f11r:
s_sleep 1
ds_read_b32 v92, v112 offset:64
s_waitcnt lgkmcnt(0)
v_cmp_ne_u32 vcc, 1, v92
s_add_u32 s63, s63, 1
s_cmp_gt_u32 s63, 0x40000
s_cbranch_scc1 L_f11
s_nop 0
s_cbranch_vccnz L_f11r
s_branch L_f11
L_f12r:
s_sleep 1
ds_read_b32 v78, v112 offset:224
s_waitcnt lgkmcnt(0)
v_cmp_ne_u32 vcc, 1, v78
s_add_u32 s63, s63, 1
s_cmp_gt_u32 s63, 0x40000
s_cbranch_scc1 L_f12
s_nop 0
s_cbranch_vccnz L_f12r
s_branch L_f12
L_f13r:
s_sleep 1
ds_read_b32 v0, v112
s_waitcnt lgkmcnt(0)
v_cmp_ne_u32 vcc, 1, v0
s_add_u32 s63, s63, 1
s_cmp_gt_u32 s63, 0x40000
s_cbranch_scc1 L_f13
s_nop 0
s_cbranch_vccnz L_f13r
s_branch L_f13
L_f14r:
s_sleep 1
ds_read_b32 v1, v112 offset:32
s_waitcnt lgkmcnt(0)
v_cmp_ne_u32 vcc, 1, v1
s_add_u32 s63, s63, 1
s_cmp_gt_u32 s63, 0x40000
s_cbranch_scc1 L_f14
s_nop 0
s_cbranch_vccnz L_f14r
s_branch L_f14
L_last:
.section .rodata,"a"
.p2align 6
.amdhsa_kernel concat_heads__ssm_conv_s4__ssm_conv_h3__prompt_kernel
  .amdhsa_next_free_vgpr 248
  .amdhsa_next_free_sgpr 66
  .amdhsa_accum_offset 248
  .amdhsa_group_segment_fixed_size 0
  .amdhsa_kernarg_size 144
  .amdhsa_user_sgpr_count 2
  .amdhsa_user_sgpr_kernarg_segment_ptr 1
  .amdhsa_system_sgpr_workgroup_id_x 1
.end_amdhsa_kernel
```
